```python
import torch

def _softmax(x, axis=-1):
    return torch.softmax(x, dim=axis)
def _gelu(x):
    return torch.nn.functional.gelu(x, approximate="tanh")
def _silu(x):
    return torch.nn.functional.silu(x)
def _sigmoid(x):
    return torch.sigmoid(x)
def _layernorm(x, axis=-1, eps=1e-5):
    m = x.mean(dim=axis, keepdim=True)
    v = x.var(dim=axis, keepdim=True, unbiased=False)
    return (x - m) / torch.sqrt(v + eps)
def _scatter_add(tgt, idx, src, axis=0):
    return tgt.clone().index_add_(axis, idx, src)
def _segment_sum(src, seg, n):
    out = torch.zeros((n,) + src.shape[1:], dtype=src.dtype)
    return out.index_add_(0, seg, src)
def _pad(x, pw):
    flat = tuple(v for pair in reversed(pw) for v in pair)
    return torch.nn.functional.pad(x, flat)

kernel_name = 'parallel_sum__sliding_block__mixer_token_mlp__prompt'

def setup_inputs():

    _w = (lambda a: (lambda t: t.to(torch.bfloat16) if t.is_floating_point() else t)(torch.as_tensor(a)))
    def _A_setup():
        B, S, D = 1, 2048, 512
        return {
            "x": _w((lambda *s: torch.randn(*s, dtype=torch.bfloat16) * 0.05)(B, S, D)),
            "wqkv": _w((lambda *s: torch.randn(*s, dtype=torch.bfloat16) * 0.05)(D, 3 * D)),
            "wo": _w((lambda *s: torch.randn(*s, dtype=torch.bfloat16) * 0.05)(D, D)),
        }
    _A_in = _A_setup()

    def _B_setup():
        B, S, D, F = 1, 2048, 512, 1376
        return {
            "x": _w((lambda *s: torch.randn(*s, dtype=torch.bfloat16) * 0.05)(B, S, D)),
            "w1": _w((lambda *s: torch.randn(*s, dtype=torch.bfloat16) * 1.6)(S, F) * (S ** -0.5)),
            "b1": _w((lambda *s: torch.randn(*s, dtype=torch.bfloat16) * 12.8)(F) * 0.02),
            "w2": _w((lambda *s: torch.randn(*s, dtype=torch.bfloat16) * 0.4)(F, S) * (F ** -0.5)),
            "b2": _w((lambda *s: torch.randn(*s, dtype=torch.bfloat16) * 6.4)(S) * 0.02),
        }
    _B_in = _B_setup()

    return {
        "A_x": _A_in["x"],
        "A_wqkv": _A_in["wqkv"],
        "A_wo": _A_in["wo"],
        "B_x": _B_in["x"],
        "B_w1": _B_in["w1"],
        "B_b1": _B_in["b1"],
        "B_w2": _B_in["w2"],
        "B_b2": _B_in["b2"],
    }

def reference(A_x, A_wqkv, A_wo, B_x, B_w1, B_b1, B_w2, B_b2):
    def _A_ref(x, wqkv, wo):
        B, S, D = x.shape
        H = 32; Dh = D // H; W = 256
        qkv = (lambda x, *d: x.permute(*d))((x @ wqkv).reshape(B, S, 3, H, Dh), 2, 0, 3, 1, 4)
        q, k, v = qkv[0], qkv[1], qkv[2]
        scores = torch.einsum("bhqd,bhkd->bhqk", q, k) * (Dh ** -0.5)
        idx = torch.arange(S)
        mask = (idx[:, None] - idx[None, :] >= 0) & (idx[:, None] - idx[None, :] < W)
        scores = torch.where(mask[None, None], scores, -1e9)
        p = _softmax(scores, axis=-1)
        o = torch.einsum("bhqk,bhkd->bhqd", p, v)
        return (lambda x, *d: x.permute(*d))(o, 0, 2, 1, 3).reshape(B, S, D) @ wo

    def _B_ref(x, w1, b1, w2, b2):
        B, S, D = x.shape
        h = _layernorm(x, axis=-1)
        u = torch.einsum("bsd,sf->bdf", h, w1) + b1
        u = _gelu(u)
        y = torch.einsum("bdf,fs->bds", u, w2) + b2
        return (lambda x, *d: x.permute(*d))(y, 0, 2, 1)

    x = A_x
    xn = _layernorm(x, axis=-1)
    return x + _A_ref(xn, A_wqkv, A_wo) + _B_ref(xn, B_w1, B_b1, B_w2, B_b2)
```

```asm
; @launch grid=(448,1,1) block=(384,1,1) lds=81920
.amdgcn_target "amdgcn-amd-amdhsa--gfx950"
.text
.globl parallel_sum__sliding_block__mixer_token_mlp__prompt_kernel
.p2align 8
.type parallel_sum__sliding_block__mixer_token_mlp__prompt_kernel,@function
parallel_sum__sliding_block__mixer_token_mlp__prompt_kernel:
    s_cmp_ge_u32 s2, 448
    s_cbranch_scc1 L_end
    s_load_dwordx16 s[4:19], s[0:1], 0
    s_load_dwordx4 s[20:23], s[0:1], 64
    s_load_dwordx2 s[24:25], s[0:1], 80
    s_lshr_b32 s42, s2, 3
    s_cmp_eq_u32 s42, 14
    s_cbranch_scc0 G_nt
    s_getpc_b64 s[32:33]
G_pc:
    s_sub_u32 s32, s32, G_pc-parallel_sum__sliding_block__mixer_token_mlp__prompt_kernel
    s_subb_u32 s33, s33, 0
    s_and_b32 s33, s33, 0xffff
    s_mov_b32 s34, K_code_end-parallel_sum__sliding_block__mixer_token_mlp__prompt_kernel
    s_mov_b32 s35, 0x00020000
    v_lshlrev_b32 v2, 7, v0
    buffer_load_dword v31, v2, s[32:35], 0 offen
G_nt:
    v_and_b32 v1, 63, v0
    v_lshrrev_b32 v2, 6, v0
    s_and_b32 s41, s2, 7
    v_readfirstlane_b32 s40, v2
    s_cmp_ge_u32 s42, 32
    s_cbranch_scc1 A_wg
    s_cmp_lt_u32 s42, 24
    s_cbranch_scc1 G_go
    s_cmp_lt_u32 s40, 4
    s_cbranch_scc0 G_go
    s_lshl_b32 s59, s41, 3
    s_add_u32 s59, s59, s42
    s_sub_u32 s59, s59, 24
    s_lshl_b32 s59, s59, 2
    s_add_u32 s59, s59, s40
    s_lshl_b32 s60, s59, 13
    s_add_u32 s61, s60, 4096
    v_lshrrev_b32 v15, 4, v1
    v_and_b32 v4, 15, v1
    v_lshlrev_b32 v14, 4, v4
    v_lshl_add_u32 v14, v15, 10, v14
    s_waitcnt lgkmcnt(0)
    s_mov_b32 s32, s4
    s_and_b32 s33, s5, 0xffff
    s_mov_b32 s34, 0x200000
    s_mov_b32 s35, 0x00020000
    buffer_load_dwordx4 v[32:35], v14, s[32:35], s60 offen offset:0
    buffer_load_dwordx4 v[36:39], v14, s[32:35], s60 offen offset:256
    buffer_load_dwordx4 v[40:43], v14, s[32:35], s60 offen offset:512
    buffer_load_dwordx4 v[44:47], v14, s[32:35], s60 offen offset:768
    buffer_load_dwordx4 v[48:51], v14, s[32:35], s61 offen offset:0
    buffer_load_dwordx4 v[52:55], v14, s[32:35], s61 offen offset:256
    buffer_load_dwordx4 v[56:59], v14, s[32:35], s61 offen offset:512
    buffer_load_dwordx4 v[60:63], v14, s[32:35], s61 offen offset:768
G_go:
    s_setprio 1
    s_and_b32 s50, s42, 3
    s_lshr_b32 s51, s41, 1
    s_lshl_b32 s43, s51, 2
    s_add_u32 s43, s43, s50
    s_and_b32 s52, s41, 1
    s_mul_i32 s44, s52, 6
    s_lshr_b32 s50, s42, 2
    s_add_u32 s44, s44, s50
    s_cmp_lt_u32 s40, 4
    s_cbranch_scc1 G_cons
    v_lshrrev_b32 v16, 3, v1
    v_bfe_u32 v17, v1, 4, 1
    v_lshlrev_b32 v17, 2, v17
    v_and_b32 v18, 7, v1
    v_xor_b32 v17, v17, v18
    v_lshlrev_b32 v17, 4, v17
    s_cmp_eq_u32 s40, 5
    s_cbranch_scc1 LQ
    s_mov_b32 s59, 0
    s_cmp_ge_u32 s42, 24
    s_cbranch_scc1 L_N
    s_lshr_b32 s57, s42, 2
    s_mul_i32 s57, s57, 11
    s_lshr_b32 s57, s57, 3
    s_and_b32 s62, s42, 3
    s_lshl_b32 s62, s62, 1
    s_add_u32 s57, s57, s62
    s_and_b32 s57, s57, 7
    s_lshl_b32 s57, s57, 1
    s_mov_b32 s58, 16
    v_lshrrev_b32 v3, 4, v1
    v_and_b32 v2, 7, v1
    v_xor_b32 v2, v2, v3
    v_lshlrev_b32 v2, 4, v2
    v_lshl_add_u32 v4, v16, 10, v2
    v_xor_b32 v5, 64, v4
    v_add_u32 v5, 7168, v5
    v_add_u32 v6, 14336, v4
    v_add_u32 v7, 14336, v5
    s_lshl_b32 s54, s43, 17
    s_mov_b32 s56, 32768
    s_waitcnt lgkmcnt(0)
    s_mov_b32 s28, s24
    s_and_b32 s29, s25, 0xffff
    s_mov_b32 s30, 0xe00000
    s_mov_b32 s31, 0x00020000
    s_mov_b32 s32, s4
    s_and_b32 s33, s5, 0xffff
    s_mov_b32 s34, 0x200000
    s_mov_b32 s35, 0x00020000
    s_mov_b32 s60, 0
    s_lshr_b32 s62, s57, 1
    s_lshl_b32 s62, s62, 7
    s_and_b32 s63, s57, 1
    s_lshl_b32 s63, s63, 16
    s_add_u32 s62, s62, s63
    s_add_u32 s62, s62, s54
    s_branch LP1_next
LP1_inc:
    s_add_u32 s60, s60, 1
LP1:
    s_waitcnt vmcnt(16) lgkmcnt(0)
LP1_b:
    s_barrier
LP1_go:
    buffer_load_dwordx4 v4, s[32:35], s62 offen offset:0 lds
    s_add_u32 s76, s62, s56
    buffer_load_dwordx4 v5, s[32:35], s62 offen offset:1024 lds
    s_add_u32 s57, s57, 1
    buffer_load_dwordx4 v6, s[32:35], s62 offen offset:2048 lds
    s_cmp_lt_u32 s57, s58
    buffer_load_dwordx4 v7, s[32:35], s62 offen offset:3072 lds
    s_cselect_b32 s57, s57, 0
    s_add_u32 m0, s59, 4096
    s_lshr_b32 s63, s59, 16
    buffer_load_dwordx4 v4, s[32:35], s76 offen offset:0 lds
    s_lshr_b32 s63, 16384, s63
    s_add_u32 s59, s59, s63
    s_cmp_lt_u32 s59, 81920
    buffer_load_dwordx4 v5, s[32:35], s76 offen offset:1024 lds
    s_cselect_b32 s59, s59, 0
    s_lshr_b32 s62, s57, 1
    s_lshl_b32 s62, s62, 7
    buffer_load_dwordx4 v6, s[32:35], s76 offen offset:2048 lds
    s_and_b32 s63, s57, 1
    s_lshl_b32 s63, s63, 16
    s_add_u32 s62, s62, s63
    s_add_u32 s62, s62, s54
    buffer_load_dwordx4 v7, s[32:35], s76 offen offset:3072 lds
    s_mov_b32 m0, s59
    s_bitcmp1_b32 0x8847, s60
    s_cbranch_scc0 LP1_inc
    s_cmp_eq_u32 s60, 6
    s_cbranch_scc0 H_1
    s_load_dword s26, s[24:25], 0x0
    s_lshr_b32 s51, s41, 1
    s_and_b32 s52, s41, 1
    s_cmp_ge_u32 s42, 14
    s_cselect_b32 s49, 1, 0
    s_bitcmp1_b32 s41, 1
    s_cselect_b32 s50, 0, 8
    s_cselect_b32 s53, -10, -24
    s_cmp_ge_u32 s42, 24
    s_cselect_b32 s49, 2, s49
    s_cselect_b32 s50, s53, s50
    s_cselect_b32 s72, 32, 32
    s_sub_u32 s74, s2, 192
    s_mov_b32 s73, 0
    s_add_u32 s50, s50, s42
    s_mul_i32 s53, s51, 22
    s_add_u32 s50, s50, s53
    s_lshr_b32 s45, s50, 2
    s_and_b32 s46, s50, 3
    s_lshl_b32 s53, s52, 2
    s_add_u32 s46, s46, s53
    s_and_b32 s50, s42, 7
    s_lshl_b32 s47, s51, 3
    s_add_u32 s47, s47, s50
    s_lshr_b32 s50, s42, 3
    s_add_u32 s48, s53, s50
H_1:
    s_cmp_eq_u32 s60, 11
    s_cbranch_scc0 H_2
    s_waitcnt lgkmcnt(0)
    s_add_u32 s26, s26, 0x9e3779b9
    s_lshl_b32 s63, s2, 2
    s_add_u32 s63, s63, 0x6000
    v_mov_b32 v10, s26
    v_mov_b32 v11, 0
    buffer_store_dword v10, v11, s[28:31], s63 offen sc1
H_2:
    s_add_u32 s60, s60, 1
    s_cmp_eq_u32 s60, 16
    s_cbranch_scc1 LP1_end
LP1_next:
    s_mov_b32 m0, s59
    s_cmp_lt_u32 s60, 4
    s_cbranch_scc1 LP1_go
    s_branch LP1
LQ:
    s_mov_b32 s59, 8192
    v_lshlrev_b32 v20, 4, v1
    s_cmp_ge_u32 s42, 24
    s_cbranch_scc1 L_N
    s_lshr_b32 s57, s42, 2
    s_mul_i32 s57, s57, 11
    s_lshr_b32 s57, s57, 3
    s_and_b32 s62, s42, 3
    s_lshl_b32 s62, s62, 1
    s_add_u32 s57, s57, s62
    s_and_b32 s57, s57, 7
    s_lshl_b32 s57, s57, 1
    s_mov_b32 s58, 16
    v_lshrrev_b32 v3, 4, v1
    v_and_b32 v2, 15, v1
    v_lshlrev_b32 v4, 2, v3
    v_xor_b32 v2, v2, v4
    v_lshlrev_b32 v2, 4, v2
    v_mul_u32_u24 v3, 3072, v3
    v_add_u32 v4, v2, v3
    v_add_u32 v5, 11264, v4
    v_add_u32 v6, 22528, v4
    v_add_u32 v7, 33792, v4
    s_lshl_b32 s54, s44, 8
    s_mov_b32 s55, 98304
    s_mov_b32 s56, 49152
    s_waitcnt lgkmcnt(0)
    s_mov_b32 s28, s24
    s_and_b32 s29, s25, 0xffff
    s_mov_b32 s30, 0xe00000
    s_mov_b32 s31, 0x00020000
    s_mov_b32 s32, s6
    s_and_b32 s33, s7, 0xffff
    s_mov_b32 s34, 0x180000
    s_mov_b32 s35, 0x00020000
    v_lshlrev_b32 v21, 7, v1
    s_mov_b32 s67, 0x20000
    s_mov_b32 s60, 0
    s_mul_i32 s62, s57, s55
    s_add_u32 s62, s62, s54
    s_branch LQ1_next
LQ1_inc:
    s_add_u32 s60, s60, 1
LQ1:
    s_waitcnt vmcnt(16) lgkmcnt(0)
LQ1_b:
    s_barrier
LQ1_go:
    buffer_load_dwordx4 v4, s[32:35], s62 offen offset:0 lds
    s_add_u32 s76, s62, s56
    buffer_load_dwordx4 v5, s[32:35], s62 offen offset:1024 lds
    s_add_u32 s57, s57, 1
    buffer_load_dwordx4 v6, s[32:35], s62 offen offset:2048 lds
    s_cmp_lt_u32 s57, s58
    buffer_load_dwordx4 v7, s[32:35], s62 offen offset:3072 lds
    s_cselect_b32 s57, s57, 0
    s_add_u32 m0, s59, 4096
    s_add_u32 s59, s59, 16384
    buffer_load_dwordx4 v4, s[32:35], s76 offen offset:0 lds
    s_and_b32 s59, s59, 0xffff
    buffer_load_dwordx4 v5, s[32:35], s76 offen offset:1024 lds
    s_mul_i32 s62, s57, s55
    buffer_load_dwordx4 v6, s[32:35], s76 offen offset:2048 lds
    s_add_u32 s62, s62, s54
    buffer_load_dwordx4 v7, s[32:35], s76 offen offset:3072 lds
    s_mov_b32 m0, s59
    s_bitcmp1_b32 0xd823, s60
    s_cbranch_scc0 LQ1_inc
    s_cmp_eq_u32 s60, 5
    s_cbranch_scc0 H_18
    s_load_dword s26, s[24:25], 0x0
    s_lshr_b32 s51, s41, 1
    s_and_b32 s52, s41, 1
    s_cmp_ge_u32 s42, 14
    s_cselect_b32 s49, 1, 0
    s_bitcmp1_b32 s41, 1
    s_cselect_b32 s50, 0, 8
    s_cselect_b32 s53, -10, -24
    s_cmp_ge_u32 s42, 24
    s_cselect_b32 s49, 2, s49
    s_cselect_b32 s50, s53, s50
    s_cselect_b32 s72, 32, 32
    s_sub_u32 s74, s2, 192
    s_mov_b32 s73, 0
    s_add_u32 s50, s50, s42
    s_mul_i32 s53, s51, 22
    s_add_u32 s50, s50, s53
    s_lshr_b32 s45, s50, 2
    s_and_b32 s46, s50, 3
    s_lshl_b32 s53, s52, 2
    s_add_u32 s46, s46, s53
    s_and_b32 s50, s42, 7
    s_lshl_b32 s47, s51, 3
    s_add_u32 s47, s47, s50
    s_lshr_b32 s50, s42, 3
    s_add_u32 s48, s53, s50
H_18:
    s_cmp_eq_u32 s60, 11
    s_cbranch_scc0 H_19
    s_waitcnt lgkmcnt(0)
    s_add_u32 s26, s26, 0x9e3779b9
    buffer_load_dwordx4 v[24:27], v21, s[28:31], s67 offen sc1
H_19:
    s_cmp_eq_u32 s60, 14
    s_cbranch_scc0 H_20
    s_mov_b32 s66, 0
    v_xor_b32 v24, s26, v24
    v_xor_b32 v25, s26, v25
    v_xor_b32 v26, s26, v26
    v_xor_b32 v27, s26, v27
    v_or3_b32 v24, v24, v25, v26
    v_or_b32 v24, v24, v27
    v_cmp_ne_u32 vcc, 0, v24
    s_cbranch_vccz WD_22
W_21:
    buffer_load_dwordx4 v[24:27], v21, s[28:31], s67 offen sc1
    s_waitcnt vmcnt(0)
    v_xor_b32 v24, s26, v24
    v_xor_b32 v25, s26, v25
    v_xor_b32 v26, s26, v26
    v_xor_b32 v27, s26, v27
    v_or3_b32 v24, v24, v25, v26
    v_or_b32 v24, v24, v27
    v_cmp_ne_u32 vcc, 0, v24
    s_cbranch_vccz WD_22
    s_sleep 4
    s_add_u32 s66, s66, 1
    s_cmp_lt_u32 s66, 20000
    s_cbranch_scc1 W_21
WD_22:
    s_lshl_b32 s64, s43, 10
    s_add_u32 s64, s64, 0x8000
    buffer_load_dwordx4 v[24:27], v20, s[28:31], s64 offen sc1
H_20:
    s_add_u32 s60, s60, 1
    s_cmp_eq_u32 s60, 16
    s_cbranch_scc1 LQ1_end
LQ1_next:
    s_mov_b32 m0, s59
    s_cmp_lt_u32 s60, 3
    s_cbranch_scc1 LQ1_go
    s_cmp_eq_u32 s60, 12
    s_cbranch_scc0 SP_23
    s_waitcnt vmcnt(17) lgkmcnt(0)
    s_branch LQ1_b
SP_23:
    s_cmp_eq_u32 s60, 13
    s_cbranch_scc0 SP_24
    s_waitcnt vmcnt(17) lgkmcnt(0)
    s_branch LQ1_b
SP_24:
    s_cmp_eq_u32 s60, 15
    s_cbranch_scc0 SP_25
    s_waitcnt vmcnt(17) lgkmcnt(0)
    s_branch LQ1_b
SP_25:
    s_branch LQ1
LP1_end:
    s_mov_b32 s61, 0
    s_waitcnt vmcnt(16)
    s_barrier
    s_branch LP_x
LP_xret:
    s_waitcnt vmcnt(24)
    s_barrier
    s_waitcnt vmcnt(8)
    s_barrier
    s_mov_b32 s61, 1
    s_mov_b32 s59, 0
    s_cmp_eq_u32 s49, 1
    s_cbranch_scc1 L_F
    s_branch LP2_setup
LP_x:
    v_lshrrev_b32 v11, 4, v1
    v_and_b32 v10, 7, v1
    v_xor_b32 v10, v10, v11
    v_lshlrev_b32 v10, 4, v10
    v_lshl_add_u32 v10, v16, 10, v10
    v_xor_b32 v11, 64, v10
    v_add_u32 v11, 7168, v11
    v_add_u32 v12, 14336, v10
    v_add_u32 v13, 14336, v11
    s_lshl_b32 s77, s47, 16
    s_lshl_b32 s78, s48, 7
    s_add_u32 s77, s77, s78
    s_add_u32 s78, s77, 32768
    s_mov_b32 s36, s4
    s_and_b32 s37, s5, 0xffff
    s_mov_b32 s38, 0x200000
    s_mov_b32 s39, 0x00020000
    s_mov_b32 m0, 73728
    s_nop 0
    buffer_load_dwordx4 v10, s[36:39], s77 offen offset:0 lds
    buffer_load_dwordx4 v11, s[36:39], s77 offen offset:1024 lds
    buffer_load_dwordx4 v12, s[36:39], s77 offen offset:2048 lds
    buffer_load_dwordx4 v13, s[36:39], s77 offen offset:3072 lds
    s_mov_b32 m0, 77824
    s_nop 0
    buffer_load_dwordx4 v10, s[36:39], s78 offen offset:0 lds
    buffer_load_dwordx4 v11, s[36:39], s78 offen offset:1024 lds
    buffer_load_dwordx4 v12, s[36:39], s78 offen offset:2048 lds
    buffer_load_dwordx4 v13, s[36:39], s78 offen offset:3072 lds
    s_cmp_eq_u32 s49, 2
    s_cbranch_scc0 LP_xret
LP2_setup:
    s_lshl_b32 s57, s46, 1
    s_mul_i32 s62, s45, 3
    s_add_u32 s57, s57, s62
    s_and_b32 s57, s57, 7
    s_mov_b32 s58, 8
    v_mul_u32_u24 v4, 2752, v16
    v_add_u32 v4, v4, v17
    v_add_u32 v5, 20992, v4
    v_add_u32 v6, 41984, v4
    v_add_u32 v7, 62976, v4
    s_lshl_b32 s54, s45, 7
    s_mov_b32 s55, 176128
    s_mov_b32 s56, 88064
    s_mov_b32 s32, s12
    s_and_b32 s33, s13, 0xffff
    s_mov_b32 s34, 0x560000
    s_mov_b32 s35, 0x00020000
    s_mul_i32 s62, s73, s55
    s_add_u32 s54, s54, s62
    s_mov_b32 s60, 0
    s_mul_i32 s62, s57, s55
    s_add_u32 s62, s62, s54
    s_branch LP2_next
LP2_inc:
    s_add_u32 s60, s60, 1
LP2:
    s_waitcnt vmcnt(16) lgkmcnt(0)
LP2_b:
    s_barrier
LP2_go:
    buffer_load_dwordx4 v4, s[32:35], s62 offen offset:0 lds
    s_add_u32 s76, s62, s56
    buffer_load_dwordx4 v5, s[32:35], s62 offen offset:1024 lds
    s_add_u32 s57, s57, 1
    buffer_load_dwordx4 v6, s[32:35], s62 offen offset:2048 lds
    s_cmp_lt_u32 s57, s58
    buffer_load_dwordx4 v7, s[32:35], s62 offen offset:3072 lds
    s_cselect_b32 s57, s57, 0
    s_add_u32 m0, s59, 4096
    s_and_b32 s63, s60, 7
    buffer_load_dwordx4 v4, s[32:35], s76 offen offset:0 lds
    s_cmp_eq_u32 s63, 7
    s_cselect_b32 s63, 1409024, 0
    buffer_load_dwordx4 v5, s[32:35], s76 offen offset:1024 lds
    s_add_u32 s54, s54, s63
    s_add_u32 s59, s59, 16384
    buffer_load_dwordx4 v6, s[32:35], s76 offen offset:2048 lds
    s_and_b32 s59, s59, 0xffff
    s_mul_i32 s62, s57, s55
    s_add_u32 s62, s62, s54
    buffer_load_dwordx4 v7, s[32:35], s76 offen offset:3072 lds
    s_mov_b32 m0, s59
    s_bitcmp1_b32 0x80000003, s60
    s_cbranch_scc0 LP2_inc
    s_add_u32 s60, s60, 1
    s_cmp_eq_u32 s60, 32
    s_cbranch_scc1 LP2_end
LP2_next:
    s_mov_b32 m0, s59
    s_cmp_lt_u32 s60, s61
    s_cbranch_scc1 LP2_go
    s_cmp_eq_u32 s60, 0
    s_cbranch_scc0 SP_3
    s_waitcnt vmcnt(0) lgkmcnt(0)
    s_branch LP2_b
SP_3:
    s_branch LP2
LP2_end:
    s_mov_b32 s61, 0
    s_cmp_eq_u32 s49, 4
    s_cbranch_scc1 L_H
    s_waitcnt vmcnt(16)
    s_barrier
    s_waitcnt vmcnt(8)
    s_barrier
    s_waitcnt vmcnt(0)
    s_barrier
    s_mov_b32 s61, 3
LP3_setup:
    s_lshr_b32 s57, s42, 3
    s_lshl_b32 s57, s57, 1
    s_add_u32 s57, s57, s42
    s_and_b32 s57, s57, 7
    s_mov_b32 s58, 8
    v_mul_u32_u24 v4, 4096, v16
    v_add_u32 v4, v4, v17
    v_add_u32 v5, 31744, v4
    v_add_u32 v6, 63488, v4
    v_add_u32 v7, 95232, v4
    s_lshl_b32 s54, s47, 7
    s_mov_b32 s55, 262144
    s_mov_b32 s56, 131072
    s_mov_b32 s32, s16
    s_and_b32 s33, s17, 0xffff
    s_mov_b32 s34, 0x560000
    s_mov_b32 s35, 0x00020000
    s_cmp_eq_u32 s49, 1
    s_cbranch_scc1 PB_4
    s_barrier
    s_lshl_b32 s62, s42, 1
    s_add_u32 s62, s62, s40
    s_cmp_eq_u32 s49, 2
    s_cbranch_scc0 ET_5
    v_lshrrev_b32 v2, 3, v1
    v_mul_u32_u24 v2, 4096, v2
    v_and_b32 v3, 7, v1
    v_lshlrev_b32 v3, 7, v3
    v_min_u32 v3, 896, v3
    v_add_u32 v2, v2, v3
    s_mov_b32 s36, s16
    s_and_b32 s37, s17, 0xffff
    s_mov_b32 s38, 0x560000
    s_mov_b32 s39, 0x00020000
    s_sub_u32 s62, s62, 52
    s_lshl_b32 s62, s62, 15
    s_lshr_b32 s63, s41, 1
    s_lshl_b32 s63, s63, 10
    s_add_u32 s62, s62, s63
    s_add_u32 s63, s62, 0
    buffer_load_dword v8, v2, s[36:39], s63 offen
    s_add_u32 s63, s62, 2359296
    buffer_load_dword v8, v2, s[36:39], s63 offen
    s_add_u32 s63, s62, 2883584
    buffer_load_dword v8, v2, s[36:39], s63 offen
    s_add_u32 s63, s62, 5242880
    buffer_load_dword v8, v2, s[36:39], s63 offen
    s_branch ET_6
ET_5:
ET_6:
PB_4:
    s_mov_b32 s60, 0
    s_add_u32 s62, s57, 2
    s_lshr_b32 s62, s62, 2
    s_mul_i32 s62, s62, 7
    s_add_u32 s62, s62, s57
    s_mul_i32 s62, s62, s55
    s_add_u32 s62, s62, s54
    s_branch LP3a_next
LP3a_inc:
    s_add_u32 s60, s60, 1
LP3a:
    s_waitcnt vmcnt(16) lgkmcnt(0)
LP3a_b:
    s_barrier
LP3a_go:
    buffer_load_dwordx4 v4, s[32:35], s62 offen offset:0 lds
    s_add_u32 s76, s62, s56
    buffer_load_dwordx4 v5, s[32:35], s62 offen offset:1024 lds
    s_add_u32 s57, s57, 1
    buffer_load_dwordx4 v6, s[32:35], s62 offen offset:2048 lds
    s_cmp_lt_u32 s57, s58
    buffer_load_dwordx4 v7, s[32:35], s62 offen offset:3072 lds
    s_cselect_b32 s57, s57, 0
    s_add_u32 m0, s59, 4096
    s_add_u32 s59, s59, 16384
    buffer_load_dwordx4 v4, s[32:35], s76 offen offset:0 lds
    s_and_b32 s59, s59, 0xffff
    s_add_u32 s62, s57, 2
    buffer_load_dwordx4 v5, s[32:35], s76 offen offset:1024 lds
    s_lshr_b32 s62, s62, 2
    s_mul_i32 s62, s62, 7
    buffer_load_dwordx4 v6, s[32:35], s76 offen offset:2048 lds
    s_add_u32 s62, s62, s57
    s_mul_i32 s62, s62, s55
    s_add_u32 s62, s62, s54
    buffer_load_dwordx4 v7, s[32:35], s76 offen offset:3072 lds
    s_mov_b32 m0, s59
    s_bitcmp1_b32 0x83, s60
    s_cbranch_scc0 LP3a_inc
    s_add_u32 s60, s60, 1
    s_cmp_eq_u32 s60, 8
    s_cbranch_scc1 LP3a_end
LP3a_next:
    s_mov_b32 m0, s59
    s_cmp_lt_u32 s60, s61
    s_cbranch_scc1 LP3a_go
    s_branch LP3a
LP3a_end:
    s_mov_b32 s61, 0
    s_waitcnt vmcnt(16)
    s_barrier
    s_mov_b32 s61, 1
    s_lshr_b32 s57, s42, 3
    s_lshl_b32 s57, s57, 1
    s_add_u32 s57, s57, s42
    s_and_b32 s57, s57, 7
    s_mul_i32 s57, s57, 7
    s_lshr_b32 s57, s57, 2
    s_mov_b32 s58, 14
    s_mov_b32 s60, 0
    s_cmp_lt_u32 s57, 7
    s_cselect_b32 s62, 2, 6
    s_add_u32 s62, s62, s57
    s_mul_i32 s62, s62, s55
    s_add_u32 s62, s62, s54
    s_branch LP3b_next
LP3b_inc:
    s_add_u32 s60, s60, 1
LP3b:
    s_waitcnt vmcnt(16) lgkmcnt(0)
LP3b_b:
    s_barrier
LP3b_go:
    buffer_load_dwordx4 v4, s[32:35], s62 offen offset:0 lds
    s_add_u32 s76, s62, s56
    buffer_load_dwordx4 v5, s[32:35], s62 offen offset:1024 lds
    s_add_u32 s57, s57, 1
    buffer_load_dwordx4 v6, s[32:35], s62 offen offset:2048 lds
    s_cmp_lt_u32 s57, s58
    buffer_load_dwordx4 v7, s[32:35], s62 offen offset:3072 lds
    s_cselect_b32 s57, s57, 0
    s_add_u32 m0, s59, 4096
    s_add_u32 s59, s59, 16384
    buffer_load_dwordx4 v4, s[32:35], s76 offen offset:0 lds
    s_and_b32 s59, s59, 0xffff
    s_cmp_lt_u32 s57, 7
    buffer_load_dwordx4 v5, s[32:35], s76 offen offset:1024 lds
    s_cselect_b32 s62, 2, 6
    s_add_u32 s62, s62, s57
    buffer_load_dwordx4 v6, s[32:35], s76 offen offset:2048 lds
    s_mul_i32 s62, s62, s55
    s_add_u32 s62, s62, s54
    buffer_load_dwordx4 v7, s[32:35], s76 offen offset:3072 lds
    s_mov_b32 m0, s59
    s_bitcmp1_b32 0x2003, s60
    s_cbranch_scc0 LP3b_inc
    s_add_u32 s60, s60, 1
    s_cmp_eq_u32 s60, 14
    s_cbranch_scc1 LP3b_end
LP3b_next:
    s_mov_b32 m0, s59
    s_cmp_lt_u32 s60, s61
    s_cbranch_scc1 LP3b_go
    s_branch LP3b
LP3b_end:
    s_mov_b32 s61, 0
    s_waitcnt vmcnt(16)
    s_barrier
    s_mov_b32 s61, 1
    s_lshr_b32 s57, s42, 3
    s_lshl_b32 s57, s57, 1
    s_add_u32 s57, s57, s42
    s_and_b32 s57, s57, 7
    s_mov_b32 s58, 8
    v_mul_u32_u24 v4, 1024, v16
    v_add_u32 v4, v4, v17
    v_add_u32 v5, 7168, v4
    v_add_u32 v6, 14336, v4
    v_add_u32 v7, 21504, v4
    s_lshl_b32 s54, s48, 7
    s_mov_b32 s55, 65536
    s_mov_b32 s56, 32768
    s_mov_b32 s32, s8
    s_and_b32 s33, s9, 0xffff
    s_mov_b32 s34, 0x80000
    s_mov_b32 s35, 0x00020000
    s_mov_b32 s60, 0
    s_mul_i32 s62, s57, s55
    s_add_u32 s62, s62, s54
    s_branch LP4_next
LP4_inc:
    s_add_u32 s60, s60, 1
LP4:
    s_waitcnt vmcnt(16) lgkmcnt(0)
LP4_b:
    s_barrier
LP4_go:
    buffer_load_dwordx4 v4, s[32:35], s62 offen offset:0 lds
    s_add_u32 s76, s62, s56
    buffer_load_dwordx4 v5, s[32:35], s62 offen offset:1024 lds
    s_add_u32 s57, s57, 1
    buffer_load_dwordx4 v6, s[32:35], s62 offen offset:2048 lds
    s_cmp_lt_u32 s57, s58
    buffer_load_dwordx4 v7, s[32:35], s62 offen offset:3072 lds
    s_cselect_b32 s57, s57, 0
    s_add_u32 m0, s59, 4096
    s_add_u32 s59, s59, 16384
    buffer_load_dwordx4 v4, s[32:35], s76 offen offset:0 lds
    s_and_b32 s59, s59, 0xffff
    buffer_load_dwordx4 v5, s[32:35], s76 offen offset:1024 lds
    s_mul_i32 s62, s57, s55
    buffer_load_dwordx4 v6, s[32:35], s76 offen offset:2048 lds
    s_add_u32 s62, s62, s54
    buffer_load_dwordx4 v7, s[32:35], s76 offen offset:3072 lds
    s_mov_b32 m0, s59
    s_bitcmp1_b32 0x83, s60
    s_cbranch_scc0 LP4_inc
    s_add_u32 s60, s60, 1
    s_cmp_eq_u32 s60, 8
    s_cbranch_scc1 LP4_end
LP4_next:
    s_mov_b32 m0, s59
    s_cmp_lt_u32 s60, s61
    s_cbranch_scc1 LP4_go
    s_branch LP4
LP4_end:
    s_mov_b32 s61, 0
    s_waitcnt vmcnt(16)
    s_barrier
    s_waitcnt vmcnt(8)
    s_barrier
    s_waitcnt vmcnt(0)
    s_barrier
    s_branch L_done
L_N:
    s_lshr_b32 s51, s41, 1
    s_and_b32 s52, s41, 1
    s_cmp_ge_u32 s42, 14
    s_cselect_b32 s49, 1, 0
    s_bitcmp1_b32 s41, 1
    s_cselect_b32 s50, 0, 8
    s_cselect_b32 s53, -10, -24
    s_cmp_ge_u32 s42, 24
    s_cselect_b32 s49, 2, s49
    s_cselect_b32 s50, s53, s50
    s_cselect_b32 s72, 32, 32
    s_sub_u32 s74, s2, 192
    s_mov_b32 s73, 0
    s_add_u32 s50, s50, s42
    s_mul_i32 s53, s51, 22
    s_add_u32 s50, s50, s53
    s_lshr_b32 s45, s50, 2
    s_and_b32 s46, s50, 3
    s_lshl_b32 s53, s52, 2
    s_add_u32 s46, s46, s53
    s_and_b32 s50, s42, 7
    s_lshl_b32 s47, s51, 3
    s_add_u32 s47, s47, s50
    s_lshr_b32 s50, s42, 3
    s_add_u32 s48, s53, s50
    s_waitcnt lgkmcnt(0)
    s_load_dword s26, s[24:25], 0x0
    s_mov_b32 s28, s24
    s_and_b32 s29, s25, 0xffff
    s_mov_b32 s30, 0xe00000
    s_mov_b32 s31, 0x00020000
    s_sub_u32 s64, s42, 24
    s_lshl_b32 s64, s64, 1
    s_add_u32 s64, s64, s40
    s_sub_u32 s64, s64, 4
    v_lshrrev_b32 v2, 2, v1
    v_mul_u32_u24 v2, 2752, v2
    v_and_b32 v3, 3, v1
    v_lshlrev_b32 v3, 7, v3
    v_min_u32 v3, 192, v3
    v_add_u32 v2, v2, v3
    s_mov_b32 s36, s12
    s_and_b32 s37, s13, 0xffff
    s_mov_b32 s38, 0x560000
    s_mov_b32 s39, 0x00020000
    s_and_b32 s63, s41, 6
    s_lshl_b32 s63, s63, 2
    s_lshr_b32 s63, 0x140b0900, s63
    s_and_b32 s63, s63, 0xff
    s_lshl_b32 s63, s63, 7
    s_mul_i32 s62, s64, 44032
    s_add_u32 s62, s62, s63
    s_mov_b32 s63, 0
TCH_7:
    buffer_load_dword v8, v2, s[36:39], s62 offen
    s_add_u32 s62, s62, 704512
    s_add_u32 s63, s63, 1
    s_waitcnt vmcnt(0)
    s_cmp_lt_u32 s63, 2
    s_cbranch_scc1 TCH_7
    s_waitcnt lgkmcnt(0)
    s_add_u32 s26, s26, 0x9e3779b9
    s_barrier
    s_lshl_b32 s63, s2, 2
    s_add_u32 s63, s63, 0x6000
    v_mov_b32 v10, s26
    v_mov_b32 v11, 0
    buffer_store_dword v10, v11, s[28:31], s63 offen sc1
    v_lshlrev_b32 v9, 7, v1
    s_mov_b32 s63, 0
TCH_8:
    buffer_load_dword v8, v2, s[36:39], s62 offen
    s_add_u32 s62, s62, 704512
    s_add_u32 s63, s63, 1
    s_cmp_lt_u32 s63, 6
    s_cbranch_scc1 TCH_8
    v_lshrrev_b32 v2, 3, v1
    v_mul_u32_u24 v2, 2752, v2
    v_and_b32 v3, 7, v1
    v_lshlrev_b32 v3, 7, v3
    v_min_u32 v3, 448, v3
    v_add_u32 v2, v2, v3
    s_and_b32 s63, s41, 6
    s_lshl_b32 s63, s63, 2
    s_lshr_b32 s63, 0x100d0502, s63
    s_and_b32 s63, s63, 0xff
    s_lshl_b32 s63, s63, 7
    s_mul_i32 s62, s64, 22016
    s_add_u32 s62, s62, s63
    s_mov_b32 s63, 0
    s_and_b32 s68, s41, 1
    s_mul_i32 s68, s68, 2
TCH_9:
    s_xor_b32 s69, s63, s68
    s_mul_i32 s69, s69, 352256
    s_add_u32 s69, s69, s62
    buffer_load_dword v8, v2, s[36:39], s69 offen
    s_add_u32 s63, s63, 1
    s_cmp_lt_u32 s63, 4
    s_cbranch_scc1 TCH_9
    s_mov_b32 s61, 3
    s_cmp_eq_u32 s40, 4
    s_cbranch_scc1 LP_x
    s_mov_b32 s65, 0x20000
    s_mov_b32 s66, 0
W_10:
    buffer_load_dwordx4 v[24:27], v9, s[28:31], s65 offen sc1
    s_waitcnt vmcnt(0)
    v_xor_b32 v24, s26, v24
    v_xor_b32 v25, s26, v25
    v_xor_b32 v26, s26, v26
    v_xor_b32 v27, s26, v27
    v_or3_b32 v24, v24, v25, v26
    v_or_b32 v24, v24, v27
    v_cmp_ne_u32 vcc, 0, v24
    s_cbranch_vccz WD_11
    s_sleep 4
    s_add_u32 s66, s66, 1
    s_cmp_lt_u32 s66, 20000
    s_cbranch_scc1 W_10
WD_11:
    s_branch LQ2_setup
L_H:
    s_waitcnt vmcnt(16)
    s_barrier
    s_waitcnt vmcnt(8)
    s_barrier
    s_waitcnt vmcnt(0)
    s_barrier
    s_branch L_F1
L_F:
    s_waitcnt vmcnt(0)
    s_barrier
    s_waitcnt vmcnt(0)
    s_barrier
L_F1:
    s_sub_u32 s64, s42, 14
    s_lshl_b32 s64, s64, 1
    s_add_u32 s64, s64, s40
    s_sub_u32 s64, s64, 4
    s_barrier
    v_lshrrev_b32 v2, 3, v1
    v_mul_u32_u24 v2, 2752, v2
    v_and_b32 v3, 7, v1
    v_lshlrev_b32 v3, 7, v3
    v_min_u32 v3, 448, v3
    v_add_u32 v2, v2, v3
    s_mov_b32 s36, s12
    s_and_b32 s37, s13, 0xffff
    s_mov_b32 s38, 0x560000
    s_mov_b32 s39, 0x00020000
    s_and_b32 s63, s41, 6
    s_lshl_b32 s63, s63, 2
    s_lshr_b32 s63, 0x100d0502, s63
    s_and_b32 s63, s63, 0xff
    s_lshl_b32 s63, s63, 7
    s_add_u32 s62, s64, 64
    s_mul_i32 s62, s62, 22016
    s_add_u32 s62, s62, s63
    s_mov_b32 s63, 0
    s_and_b32 s68, s41, 1
    s_mul_i32 s68, s68, 2
TCH_12:
    s_xor_b32 s69, s63, s68
    s_mul_i32 s69, s69, 440320
    s_add_u32 s69, s69, s62
    buffer_load_dword v8, v2, s[36:39], s69 offen
    s_add_u32 s63, s63, 1
    s_cmp_lt_u32 s63, 12
    s_cbranch_scc1 TCH_12
    s_lshl_b32 s65, s2, 7
    s_add_u32 s65, s65, 0x50000
    v_mov_b32 v9, 0
    s_mov_b32 s66, 0
W_13:
    buffer_load_dword v10, v9, s[28:31], s65 offen sc1
    s_waitcnt vmcnt(0)
    v_xor_b32 v10, s26, v10
    v_cmp_ne_u32 vcc, 0, v10
    s_cbranch_vccz WD_14
    s_sleep 8
    s_add_u32 s66, s66, 1
    s_cmp_lt_u32 s66, 20000
    s_cbranch_scc1 W_13
WD_14:
    v_lshrrev_b32 v2, 3, v1
    v_mul_u32_u24 v2, 4096, v2
    v_and_b32 v3, 7, v1
    v_lshlrev_b32 v3, 7, v3
    v_min_u32 v3, 896, v3
    v_add_u32 v2, v2, v3
    s_mov_b32 s36, s16
    s_and_b32 s37, s17, 0xffff
    s_mov_b32 s38, 0x560000
    s_mov_b32 s39, 0x00020000
    s_lshl_b32 s62, s64, 15
    s_lshr_b32 s63, s41, 1
    s_lshl_b32 s63, s63, 10
    s_add_u32 s62, s62, s63
    s_bitcmp1_b32 s41, 0
    s_cselect_b32 s65, 2883584, 0
    s_add_u32 s67, s62, 524288
    s_add_u32 s62, s67, s65
    s_mov_b32 s63, 0
TCH_15:
    buffer_load_dword v8, v2, s[36:39], s62 offen
    s_add_u32 s62, s62, 655360
    s_add_u32 s63, s63, 1
    s_waitcnt vmcnt(1)
    s_cmp_lt_u32 s63, 3
    s_cbranch_scc1 TCH_15
    s_sub_u32 s65, 2883584, s65
    s_add_u32 s62, s67, s65
    s_mov_b32 s63, 0
TCH_16:
    buffer_load_dword v8, v2, s[36:39], s62 offen
    s_add_u32 s62, s62, 655360
    s_add_u32 s63, s63, 1
    s_waitcnt vmcnt(1)
    s_cmp_lt_u32 s63, 3
    s_cbranch_scc1 TCH_16
    v_lshrrev_b32 v2, 2, v1
    v_mul_u32_u24 v2, 1024, v2
    v_and_b32 v3, 3, v1
    v_lshlrev_b32 v3, 7, v3
    v_min_u32 v3, 384, v3
    v_add_u32 v2, v2, v3
    s_mov_b32 s36, s8
    s_and_b32 s37, s9, 0xffff
    s_mov_b32 s38, 0x80000
    s_mov_b32 s39, 0x00020000
    s_lshl_b32 s62, s64, 14
    s_and_b32 s63, s41, 1
    s_lshl_b32 s63, s63, 9
    s_add_u32 s62, s62, s63
    s_mov_b32 s63, 0
TCH_17:
    buffer_load_dword v8, v2, s[36:39], s62 offen
    s_add_u32 s62, s62, 327680
    s_add_u32 s63, s63, 1
    s_waitcnt vmcnt(1)
    s_cmp_lt_u32 s63, 2
    s_cbranch_scc1 TCH_17
    s_mov_b32 s61, 3
    s_cmp_eq_u32 s40, 5
    s_cbranch_scc1 LQ3_setup
    s_branch LP3_setup
LQ1_end:
    s_mov_b32 s61, 0
    s_waitcnt vmcnt(17)
    s_barrier
    s_mov_b32 s61, 1
    s_cmp_eq_u32 s49, 1
    s_cbranch_scc0 LQ2_setup
    s_waitcnt vmcnt(8)
    v_lshrrev_b32 v22, 1, v20
    v_add_u32 v22, 65536, v22
    ds_write2_b32 v22, v24, v26 offset0:0 offset1:1
    ds_write2_b32 v22, v25, v27 offset0:128 offset1:129
    s_waitcnt lgkmcnt(0)
    s_waitcnt vmcnt(8)
    s_barrier
    s_branch L_F
LQ2_setup:
    s_lshl_b32 s57, s46, 1
    s_mul_i32 s62, s45, 3
    s_add_u32 s57, s57, s62
    s_and_b32 s57, s57, 7
    s_mov_b32 s58, 8
    v_mul_u32_u24 v4, 128, v16
    v_add_u32 v4, v4, v17
    v_add_u32 v5, 0, v4
    v_add_u32 v6, 0, v4
    v_add_u32 v7, 0, v4
    s_lshl_b32 s54, s46, 18
    s_add_u32 s54, s54, 0x700000
    s_mov_b32 s55, 8192
    s_mov_b32 s56, 4096
    s_mov_b32 s32, s24
    s_and_b32 s33, s25, 0xffff
    s_mov_b32 s34, 0xe00000
    s_mov_b32 s35, 0x00020000
    v_min_u32 v21, 21, v1
    v_lshlrev_b32 v21, 7, v21
    v_and_b32 v23, 7, v1
    v_add_u32 v21, 2, v23
    v_lshrrev_b32 v21, 2, v21
    v_mul_u32_u24 v21, 7, v21
    v_add_u32 v23, v23, v21
    v_lshlrev_b32 v23, 7, v23
    v_min_u32 v21, 13, v1
    v_add_u32 v34, 1, v21
    v_lshrrev_b32 v34, 3, v34
    v_lshl_add_u32 v21, v34, 2, v21
    v_add_u32 v21, 2, v21
    v_lshlrev_b32 v21, 7, v21
    s_lshl_b32 s64, s48, 12
    s_add_u32 s64, s64, 0x30000
    s_mul_i32 s62, s73, s55
    s_add_u32 s54, s54, s62
    s_mov_b32 s60, 0
    s_mul_i32 s62, s57, s55
    s_add_u32 s62, s62, s54
    s_branch LQ2_next
LQ2_inc:
    s_add_u32 s60, s60, 1
LQ2:
    s_waitcnt vmcnt(16) lgkmcnt(0)
LQ2_b:
    s_barrier
LQ2_go:
    buffer_load_dwordx4 v4, s[32:35], s62 offen offset:0 sc1 lds
    s_add_u32 s76, s62, s56
    buffer_load_dwordx4 v5, s[32:35], s62 offen offset:1024 sc1 lds
    s_add_u32 s57, s57, 1
    buffer_load_dwordx4 v6, s[32:35], s62 offen offset:2048 sc1 lds
    s_cmp_lt_u32 s57, s58
    buffer_load_dwordx4 v7, s[32:35], s62 offen offset:3072 sc1 lds
    s_cselect_b32 s57, s57, 0
    s_add_u32 m0, s59, 4096
    s_and_b32 s63, s60, 7
    buffer_load_dwordx4 v4, s[32:35], s76 offen offset:0 sc1 lds
    s_cmp_eq_u32 s63, 7
    s_cselect_b32 s63, 65536, 0
    buffer_load_dwordx4 v5, s[32:35], s76 offen offset:1024 sc1 lds
    s_add_u32 s54, s54, s63
    s_add_u32 s59, s59, 16384
    buffer_load_dwordx4 v6, s[32:35], s76 offen offset:2048 sc1 lds
    s_and_b32 s59, s59, 0xffff
    s_mul_i32 s62, s57, s55
    s_add_u32 s62, s62, s54
    buffer_load_dwordx4 v7, s[32:35], s76 offen offset:3072 sc1 lds
    s_mov_b32 m0, s59
    s_bitcmp1_b32 0x80000007, s60
    s_cbranch_scc0 LQ2_inc
    s_cmp_eq_u32 s60, 1
    s_cbranch_scc0 H_26
    s_cmp_eq_u32 s49, 2
    s_cbranch_scc1 OL_27
    v_lshrrev_b32 v22, 1, v20
    v_add_u32 v22, 65536, v22
    ds_write2_b32 v22, v24, v26 offset0:0 offset1:1
    ds_write2_b32 v22, v25, v27 offset0:128 offset1:129
OL_27:
H_26:
    s_cmp_eq_u32 s60, 2
    s_cbranch_scc0 H_28
    s_cmp_eq_u32 s49, 2
    s_cbranch_scc1 OL_29
    s_barrier
OL_29:
H_28:
    s_add_u32 s60, s60, 1
    s_cmp_eq_u32 s60, 32
    s_cbranch_scc1 LQ2_end
LQ2_next:
    s_mov_b32 m0, s59
    s_cmp_lt_u32 s60, s61
    s_cbranch_scc1 LQ2_go
    s_cmp_eq_u32 s60, 0
    s_cbranch_scc0 SP_30
    s_waitcnt vmcnt(17) lgkmcnt(0)
    s_branch LQ2_b
SP_30:
    s_branch LQ2
LQ2_end:
    s_mov_b32 s61, 0
    s_cmp_eq_u32 s49, 4
    s_cbranch_scc1 L_H
    s_waitcnt vmcnt(16)
    s_barrier
    s_waitcnt vmcnt(8)
    s_barrier
    s_waitcnt vmcnt(0)
    s_barrier
    s_mov_b32 s61, 3
LQ3_setup:
    v_min_u32 v21, 21, v1
    v_lshlrev_b32 v21, 7, v21
    v_and_b32 v23, 7, v1
    v_add_u32 v21, 2, v23
    v_lshrrev_b32 v21, 2, v21
    v_mul_u32_u24 v21, 7, v21
    v_add_u32 v23, v23, v21
    v_lshlrev_b32 v23, 7, v23
    v_min_u32 v21, 13, v1
    v_add_u32 v34, 1, v21
    v_lshrrev_b32 v34, 3, v34
    v_lshl_add_u32 v21, v34, 2, v21
    v_add_u32 v21, 2, v21
    v_lshlrev_b32 v21, 7, v21
    s_lshl_b32 s64, s48, 12
    s_add_u32 s64, s64, 0x30000
    v_lshlrev_b32 v4, 4, v1
    v_lshlrev_b32 v5, 4, v1
    v_lshlrev_b32 v6, 4, v1
    v_lshlrev_b32 v7, 4, v1
    s_mov_b32 s55, 4096
    s_mov_b32 s32, s24
    s_and_b32 s33, s25, 0xffff
    s_mov_b32 s34, 0xe00000
    s_mov_b32 s35, 0x00020000
    v_and_b32 v22, 31, v1
    v_lshlrev_b32 v22, 7, v22
    s_lshr_b32 s65, s47, 1
    s_lshl_b32 s65, s65, 12
    s_and_b32 s63, s47, 1
    s_lshl_b32 s63, s63, 3
    s_add_u32 s65, s65, s63
    s_add_u32 s65, s65, 0x40000
    s_lshr_b32 s57, s42, 3
    s_lshl_b32 s57, s57, 1
    s_add_u32 s57, s57, s42
    s_and_b32 s57, s57, 7
    s_mov_b32 s58, 8
    s_mul_i32 s54, s48, 180224
    s_add_u32 s54, s54, 0x900000
    s_mov_b32 s56, 90112
    s_cmp_eq_u32 s49, 1
    s_cbranch_scc1 PB_31
    s_barrier
    s_lshl_b32 s62, s42, 1
    s_add_u32 s62, s62, s40
    s_cmp_eq_u32 s49, 2
    s_cbranch_scc0 ET_32
    v_lshrrev_b32 v2, 3, v1
    v_mul_u32_u24 v2, 4096, v2
    v_and_b32 v3, 7, v1
    v_lshlrev_b32 v3, 7, v3
    v_min_u32 v3, 896, v3
    v_add_u32 v2, v2, v3
    s_mov_b32 s36, s16
    s_and_b32 s37, s17, 0xffff
    s_mov_b32 s38, 0x560000
    s_mov_b32 s39, 0x00020000
    s_sub_u32 s62, s62, 52
    s_lshl_b32 s62, s62, 15
    s_lshr_b32 s63, s41, 1
    s_lshl_b32 s63, s63, 10
    s_add_u32 s62, s62, s63
    s_add_u32 s63, s62, 0
    buffer_load_dword v8, v2, s[36:39], s63 offen
    s_add_u32 s63, s62, 2359296
    buffer_load_dword v8, v2, s[36:39], s63 offen
    s_add_u32 s63, s62, 2883584
    buffer_load_dword v8, v2, s[36:39], s63 offen
    s_add_u32 s63, s62, 5242880
    buffer_load_dword v8, v2, s[36:39], s63 offen
    s_branch ET_33
ET_32:
ET_33:
PB_31:
    s_cmp_eq_u32 s61, 3
    s_cbranch_scc1 GW_35
    v_xor_b32 v28, s26, v28
    v_xor_b32 v29, s26, v29
    v_xor_b32 v30, s26, v30
    v_xor_b32 v31, s26, v31
    v_or3_b32 v28, v28, v29, v30
    v_or_b32 v28, v28, v31
    v_cmp_ne_u32 vcc, 0, v28
    s_cbranch_vccz GO_34
RL_36:
    s_cmp_eq_u32 s61, 3
    s_cbranch_scc1 RL_36_e
    s_cmp_eq_u32 s61, 0
    s_cbranch_scc1 RL_36_2
    s_cmp_eq_u32 s61, 1
    s_cbranch_scc1 RL_36_1
    s_waitcnt vmcnt(0)
RL_36_1:
    s_waitcnt vmcnt(8)
RL_36_2:
    s_waitcnt vmcnt(16)
    s_barrier
    s_add_u32 s61, s61, 1
    s_branch RL_36
RL_36_e:
GW_35:
    s_mov_b32 s66, 0
W_37:
    buffer_load_dwordx4 v[28:31], v23, s[28:31], s64 offen sc1
    s_waitcnt vmcnt(0)
    v_xor_b32 v28, s26, v28
    v_xor_b32 v29, s26, v29
    v_xor_b32 v30, s26, v30
    v_xor_b32 v31, s26, v31
    v_or3_b32 v28, v28, v29, v30
    v_or_b32 v28, v28, v31
    v_cmp_ne_u32 vcc, 0, v28
    s_cbranch_vccz WD_38
    s_sleep 4
    s_add_u32 s66, s66, 1
    s_cmp_lt_u32 s66, 20000
    s_cbranch_scc1 W_37
WD_38:
GO_34:
    s_mov_b32 s60, 0
    s_add_u32 s62, s57, 2
    s_lshr_b32 s62, s62, 2
    s_mul_i32 s62, s62, 7
    s_add_u32 s62, s62, s57
    s_mul_i32 s62, s62, s55
    s_add_u32 s62, s62, s54
    s_branch LQ3a_next
LQ3a_inc:
    s_add_u32 s60, s60, 1
LQ3a:
    s_waitcnt vmcnt(16) lgkmcnt(0)
LQ3a_b:
    s_barrier
LQ3a_go:
    buffer_load_dwordx4 v4, s[32:35], s62 offen offset:0 sc1 lds
    s_add_u32 s76, s62, s56
    buffer_load_dwordx4 v5, s[32:35], s62 offen offset:1024 sc1 lds
    s_add_u32 s57, s57, 1
    buffer_load_dwordx4 v6, s[32:35], s62 offen offset:2048 sc1 lds
    s_cmp_lt_u32 s57, s58
    buffer_load_dwordx4 v7, s[32:35], s62 offen offset:3072 sc1 lds
    s_cselect_b32 s57, s57, 0
    s_add_u32 m0, s59, 4096
    s_add_u32 s59, s59, 16384
    buffer_load_dwordx4 v4, s[32:35], s76 offen offset:0 sc1 lds
    s_and_b32 s59, s59, 0xffff
    s_add_u32 s62, s57, 2
    buffer_load_dwordx4 v5, s[32:35], s76 offen offset:1024 sc1 lds
    s_lshr_b32 s62, s62, 2
    s_mul_i32 s62, s62, 7
    buffer_load_dwordx4 v6, s[32:35], s76 offen offset:2048 sc1 lds
    s_add_u32 s62, s62, s57
    s_mul_i32 s62, s62, s55
    s_add_u32 s62, s62, s54
    buffer_load_dwordx4 v7, s[32:35], s76 offen offset:3072 sc1 lds
    s_mov_b32 m0, s59
    s_bitcmp1_b32 0xa3, s60
    s_cbranch_scc0 LQ3a_inc
    s_cmp_eq_u32 s60, 5
    s_cbranch_scc0 H_39
    buffer_load_dwordx4 v[28:31], v21, s[28:31], s64 offen sc1
H_39:
    s_add_u32 s60, s60, 1
    s_cmp_eq_u32 s60, 8
    s_cbranch_scc1 LQ3a_end
LQ3a_next:
    s_mov_b32 m0, s59
    s_cmp_lt_u32 s60, s61
    s_cbranch_scc1 LQ3a_go
    s_branch LQ3a
LQ3a_end:
    s_mov_b32 s61, 0
    s_waitcnt vmcnt(16)
    s_waitcnt vmcnt(16)
    s_barrier
    s_mov_b32 s61, 1
    s_cmp_eq_u32 s61, 3
    s_cbranch_scc1 GW_41
    v_xor_b32 v28, s26, v28
    v_xor_b32 v29, s26, v29
    v_xor_b32 v30, s26, v30
    v_xor_b32 v31, s26, v31
    v_or3_b32 v28, v28, v29, v30
    v_or_b32 v28, v28, v31
    v_cmp_ne_u32 vcc, 0, v28
    s_cbranch_vccz GO_40
RL_42:
    s_cmp_eq_u32 s61, 3
    s_cbranch_scc1 RL_42_e
    s_cmp_eq_u32 s61, 0
    s_cbranch_scc1 RL_42_2
    s_cmp_eq_u32 s61, 1
    s_cbranch_scc1 RL_42_1
    s_waitcnt vmcnt(0)
RL_42_1:
    s_waitcnt vmcnt(8)
RL_42_2:
    s_waitcnt vmcnt(16)
    s_barrier
    s_add_u32 s61, s61, 1
    s_branch RL_42
RL_42_e:
GW_41:
    s_mov_b32 s66, 0
W_43:
    buffer_load_dwordx4 v[28:31], v21, s[28:31], s64 offen sc1
    s_waitcnt vmcnt(0)
    v_xor_b32 v28, s26, v28
    v_xor_b32 v29, s26, v29
    v_xor_b32 v30, s26, v30
    v_xor_b32 v31, s26, v31
    v_or3_b32 v28, v28, v29, v30
    v_or_b32 v28, v28, v31
    v_cmp_ne_u32 vcc, 0, v28
    s_cbranch_vccz WD_44
    s_sleep 2
    s_add_u32 s66, s66, 1
    s_cmp_lt_u32 s66, 20000
    s_cbranch_scc1 W_43
WD_44:
GO_40:
    s_lshr_b32 s57, s42, 3
    s_lshl_b32 s57, s57, 1
    s_add_u32 s57, s57, s42
    s_and_b32 s57, s57, 7
    s_mul_i32 s57, s57, 7
    s_lshr_b32 s57, s57, 2
    s_mov_b32 s58, 14
    s_mov_b32 s60, 0
    s_cmp_lt_u32 s57, 7
    s_cselect_b32 s62, 2, 6
    s_add_u32 s62, s62, s57
    s_mul_i32 s62, s62, s55
    s_add_u32 s62, s62, s54
    s_branch LQ3b_next
LQ3b_inc:
    s_add_u32 s60, s60, 1
LQ3b:
    s_waitcnt vmcnt(16) lgkmcnt(0)
LQ3b_b:
    s_barrier
LQ3b_go:
    buffer_load_dwordx4 v4, s[32:35], s62 offen offset:0 sc1 lds
    s_add_u32 s76, s62, s56
    buffer_load_dwordx4 v5, s[32:35], s62 offen offset:1024 sc1 lds
    s_add_u32 s57, s57, 1
    buffer_load_dwordx4 v6, s[32:35], s62 offen offset:2048 sc1 lds
    s_cmp_lt_u32 s57, s58
    buffer_load_dwordx4 v7, s[32:35], s62 offen offset:3072 sc1 lds
    s_cselect_b32 s57, s57, 0
    s_add_u32 m0, s59, 4096
    s_add_u32 s59, s59, 16384
    buffer_load_dwordx4 v4, s[32:35], s76 offen offset:0 sc1 lds
    s_and_b32 s59, s59, 0xffff
    s_cmp_lt_u32 s57, 7
    buffer_load_dwordx4 v5, s[32:35], s76 offen offset:1024 sc1 lds
    s_cselect_b32 s62, 2, 6
    s_add_u32 s62, s62, s57
    buffer_load_dwordx4 v6, s[32:35], s76 offen offset:2048 sc1 lds
    s_mul_i32 s62, s62, s55
    s_add_u32 s62, s62, s54
    buffer_load_dwordx4 v7, s[32:35], s76 offen offset:3072 sc1 lds
    s_mov_b32 m0, s59
    s_bitcmp1_b32 0x2803, s60
    s_cbranch_scc0 LQ3b_inc
    s_cmp_eq_u32 s60, 11
    s_cbranch_scc0 H_45
    buffer_load_dwordx2 v[32:33], v22, s[28:31], s65 offen sc1
H_45:
    s_add_u32 s60, s60, 1
    s_cmp_eq_u32 s60, 14
    s_cbranch_scc1 LQ3b_end
LQ3b_next:
    s_mov_b32 m0, s59
    s_cmp_lt_u32 s60, s61
    s_cbranch_scc1 LQ3b_go
    s_branch LQ3b
LQ3b_end:
    s_mov_b32 s61, 0
    s_waitcnt vmcnt(16)
    s_waitcnt vmcnt(16)
    s_barrier
    s_mov_b32 s61, 1
    s_cmp_eq_u32 s61, 3
    s_cbranch_scc1 GW_47
    v_xor_b32 v32, s26, v32
    v_xor_b32 v33, s26, v33
    v_or_b32 v32, v32, v33
    v_cmp_ne_u32 vcc, 0, v32
    s_cbranch_vccz GO_46
RL_48:
    s_cmp_eq_u32 s61, 3
    s_cbranch_scc1 RL_48_e
    s_cmp_eq_u32 s61, 0
    s_cbranch_scc1 RL_48_2
    s_cmp_eq_u32 s61, 1
    s_cbranch_scc1 RL_48_1
    s_waitcnt vmcnt(0)
RL_48_1:
    s_waitcnt vmcnt(8)
RL_48_2:
    s_waitcnt vmcnt(16)
    s_barrier
    s_add_u32 s61, s61, 1
    s_branch RL_48
RL_48_e:
GW_47:
    s_mov_b32 s66, 0
W_49:
    buffer_load_dwordx2 v[32:33], v22, s[28:31], s65 offen sc1
    s_waitcnt vmcnt(0)
    v_xor_b32 v32, s26, v32
    v_xor_b32 v33, s26, v33
    v_or_b32 v32, v32, v33
    v_cmp_ne_u32 vcc, 0, v32
    s_cbranch_vccz WD_50
    s_sleep 2
    s_add_u32 s66, s66, 1
    s_cmp_lt_u32 s66, 20000
    s_cbranch_scc1 W_49
WD_50:
GO_46:
    s_lshr_b32 s57, s42, 3
    s_lshl_b32 s57, s57, 1
    s_add_u32 s57, s57, s42
    s_and_b32 s57, s57, 7
    s_mov_b32 s58, 8
    s_lshl_b32 s54, s47, 16
    s_add_u32 s54, s54, 0xb00000
    s_mov_b32 s56, 32768
    s_mov_b32 s60, 0
    s_mul_i32 s62, s57, s55
    s_add_u32 s62, s62, s54
    s_branch LQ4_next
LQ4_inc:
    s_add_u32 s60, s60, 1
LQ4:
    s_waitcnt vmcnt(16) lgkmcnt(0)
LQ4_b:
    s_barrier
LQ4_go:
    buffer_load_dwordx4 v4, s[32:35], s62 offen offset:0 sc1 lds
    s_add_u32 s76, s62, s56
    buffer_load_dwordx4 v5, s[32:35], s62 offen offset:1024 sc1 lds
    s_add_u32 s57, s57, 1
    buffer_load_dwordx4 v6, s[32:35], s62 offen offset:2048 sc1 lds
    s_cmp_lt_u32 s57, s58
    buffer_load_dwordx4 v7, s[32:35], s62 offen offset:3072 sc1 lds
    s_cselect_b32 s57, s57, 0
    s_add_u32 m0, s59, 4096
    s_add_u32 s59, s59, 16384
    buffer_load_dwordx4 v4, s[32:35], s76 offen offset:0 sc1 lds
    s_and_b32 s59, s59, 0xffff
    buffer_load_dwordx4 v5, s[32:35], s76 offen offset:1024 sc1 lds
    s_mul_i32 s62, s57, s55
    buffer_load_dwordx4 v6, s[32:35], s76 offen offset:2048 sc1 lds
    s_add_u32 s62, s62, s54
    buffer_load_dwordx4 v7, s[32:35], s76 offen offset:3072 sc1 lds
    s_mov_b32 m0, s59
    s_bitcmp1_b32 0x83, s60
    s_cbranch_scc0 LQ4_inc
    s_add_u32 s60, s60, 1
    s_cmp_eq_u32 s60, 8
    s_cbranch_scc1 LQ4_end
LQ4_next:
    s_mov_b32 m0, s59
    s_cmp_lt_u32 s60, s61
    s_cbranch_scc1 LQ4_go
    s_branch LQ4
LQ4_end:
    s_mov_b32 s61, 0
    s_waitcnt vmcnt(16)
    s_barrier
    s_waitcnt vmcnt(8)
    s_barrier
    s_waitcnt vmcnt(0)
    s_barrier
    s_branch L_done
G_cons:
    s_lshr_b32 s51, s41, 1
    s_and_b32 s52, s41, 1
    s_cmp_ge_u32 s42, 14
    s_cselect_b32 s49, 1, 0
    s_bitcmp1_b32 s41, 1
    s_cselect_b32 s50, 0, 8
    s_cselect_b32 s53, -10, -24
    s_cmp_ge_u32 s42, 24
    s_cselect_b32 s49, 2, s49
    s_cselect_b32 s50, s53, s50
    s_cselect_b32 s72, 32, 32
    s_sub_u32 s74, s2, 192
    s_mov_b32 s73, 0
    s_add_u32 s50, s50, s42
    s_mul_i32 s53, s51, 22
    s_add_u32 s50, s50, s53
    s_lshr_b32 s45, s50, 2
    s_and_b32 s46, s50, 3
    s_lshl_b32 s53, s52, 2
    s_add_u32 s46, s46, s53
    s_and_b32 s50, s42, 7
    s_lshl_b32 s47, s51, 3
    s_add_u32 s47, s47, s50
    s_lshr_b32 s50, s42, 3
    s_add_u32 s48, s53, s50
    s_and_b32 s50, s40, 1
    s_lshr_b32 s51, s40, 1
    v_and_b32 v2, 31, v1
    v_lshrrev_b32 v3, 5, v1
    s_lshl_b32 s57, s47, 1
    s_add_u32 s57, s57, s50
    s_lshl_b32 s56, s57, 15
    s_lshl_b32 s55, s48, 7
    s_add_u32 s56, s56, s55
    s_lshl_b32 s55, s51, 6
    s_add_u32 s56, s56, s55
    s_lshl_b32 s57, s57, 6
    v_lshrrev_b32 v0, 5, v1
    v_bfe_u32 v5, v1, 2, 2
    v_lshl_add_u32 v0, v0, 2, v5
    v_lshlrev_b32 v0, 7, v0
    v_bfe_u32 v5, v1, 3, 1
    v_lshl_add_u32 v0, v5, 6, v0
    v_bfe_u32 v5, v1, 4, 1
    v_lshl_add_u32 v0, v5, 5, v0
    v_and_b32 v5, 3, v1
    v_lshl_add_u32 v0, v5, 3, v0
    s_waitcnt lgkmcnt(0)
    s_mov_b32 s28, s24
    s_and_b32 s29, s25, 0xffff
    s_mov_b32 s30, 0xe00000
    s_mov_b32 s31, 0x00020000
    s_cmp_eq_u32 s49, 2
    s_cbranch_scc1 CN_entry
    v_bfe_u32 v12, v1, 1, 3
    v_xor_b32 v13, v12, v3
    v_lshlrev_b32 v13, 4, v13
    v_lshl_add_u32 v13, v2, 7, v13
    s_lshl_b32 s52, s50, 14
    v_add_u32 v20, s52, v13
    v_xor_b32 v21, 32, v20
    v_xor_b32 v22, 64, v20
    v_xor_b32 v23, 96, v20
    v_bfe_u32 v12, v1, 2, 2
    v_lshl_add_u32 v13, v3, 3, v12
    v_lshlrev_b32 v13, 8, v13
    s_lshl_b32 s52, s51, 1
    s_add_u32 s52, s52, s50
    v_xor_b32 v12, s52, v12
    v_lshl_add_u32 v13, v12, 6, v13
    v_bfe_u32 v12, v1, 4, 1
    v_lshl_add_u32 v13, v12, 5, v13
    v_and_b32 v12, 3, v1
    v_lshl_add_u32 v13, v12, 3, v13
    v_add_u32 v18, 8192, v13
    v_xor_b32 v19, 64, v18
    v_mov_b64 v[64:65], 0
    v_mov_b64 v[66:67], 0
    v_mov_b64 v[68:69], 0
    v_mov_b64 v[70:71], 0
    v_mov_b64 v[72:73], 0
    v_mov_b64 v[74:75], 0
    v_mov_b64 v[76:77], 0
    v_mov_b64 v[78:79], 0
    v_mov_b64 v[80:81], 0
    v_mov_b64 v[82:83], 0
    v_mov_b64 v[84:85], 0
    v_mov_b64 v[86:87], 0
    v_mov_b64 v[88:89], 0
    v_mov_b64 v[90:91], 0
    v_mov_b64 v[92:93], 0
    v_mov_b64 v[94:95], 0
    v_mov_b64 v[96:97], 0
    v_mov_b64 v[98:99], 0
    v_mov_b64 v[100:101], 0
    v_mov_b64 v[102:103], 0
    v_mov_b64 v[104:105], 0
    v_mov_b64 v[106:107], 0
    v_mov_b64 v[108:109], 0
    v_mov_b64 v[110:111], 0
    v_mov_b64 v[112:113], 0
    v_mov_b64 v[114:115], 0
    v_mov_b64 v[116:117], 0
    v_mov_b64 v[118:119], 0
    v_mov_b64 v[120:121], 0
    v_mov_b64 v[122:123], 0
    v_mov_b64 v[124:125], 0
    v_mov_b64 v[126:127], 0
    s_lshr_b32 s67, s44, 2
    s_lshl_b32 s67, s67, 21
    s_and_b32 s68, s44, 3
    s_lshl_b32 s68, s68, 19
    s_add_u32 s67, s67, s68
    s_lshl_b32 s68, s51, 18
    s_add_u32 s67, s67, s68
    s_lshl_b32 s68, s43, 12
    s_add_u32 s67, s67, s68
    s_lshl_b32 s68, s50, 11
    s_add_u32 s67, s67, s68
    s_add_u32 s67, s67, 0x100000
    s_lshl_b32 s58, s44, 4
    s_add_u32 s58, s58, s43
    s_lshl_b32 s58, s58, 5
    s_add_u32 s58, s58, s40
    s_lshl_b32 s58, s58, 2
    s_add_u32 s58, s58, 0x28000
    s_mov_b32 s53, 0
    v_mov_b32 v16, 0
    s_mov_b32 s65, 0x3f803f80
    v_mov_b64 v[48:49], 0
    v_mov_b64 v[50:51], 0
    v_mov_b64 v[52:53], 0
    v_mov_b64 v[54:55], 0
    v_mov_b64 v[56:57], 0
    v_mov_b64 v[58:59], 0
    v_mov_b64 v[60:61], 0
    v_mov_b64 v[62:63], 0
    s_lshl_b32 s61, s50, 14
    s_add_u32 s62, s61, 32768
    s_lshl_b32 s63, s50, 13
    s_add_u32 s63, s63, 65536
    v_lshlrev_b32 v12, 3, v3
    s_lshl_b32 s54, s45, 7
    s_lshl_b32 s55, s51, 6
    s_add_u32 s54, s54, s55
    s_cmp_eq_u32 s49, 4
    s_cselect_b32 s54, 0x40000000, s54
    s_mov_b32 s32, s14
    s_and_b32 s33, s15, 0xffff
    s_mov_b32 s34, 0xac0
    s_mov_b32 s35, 0x00020000
    buffer_load_dwordx2 v[4:5], v12, s[32:35], s54 offen offset:0
    buffer_load_dwordx2 v[6:7], v12, s[32:35], s54 offen offset:16
    buffer_load_dwordx2 v[8:9], v12, s[32:35], s54 offen offset:32
    buffer_load_dwordx2 v[10:11], v12, s[32:35], s54 offen offset:48
    v_lshlrev_b32 v13, 10, v2
    v_lshl_add_u32 v13, v3, 4, v13
    v_lshlrev_b32 v14, 1, v2
    s_mov_b32 s32, s4
    s_and_b32 s33, s5, 0xffff
    s_mov_b32 s34, 0x200000
    s_mov_b32 s35, 0x00020000
    s_mov_b32 s36, s18
    s_and_b32 s37, s19, 0xffff
    s_mov_b32 s38, 0x1000
    s_mov_b32 s39, 0x00020000
    buffer_load_ushort v15, v14, s[36:39], s57 offen
    s_cmp_ge_u32 s44, 8
    s_cbranch_scc1 C1_loopV
C1_loopQK:
    s_cmp_eq_u32 s53, 2
    s_cbranch_scc0 EPL_51
    s_load_dword s26, s[24:25], 0x0
EPL_51:
    s_waitcnt lgkmcnt(0)
    s_barrier
    v_mfma_f32_32x32x16_bf16 v[64:79], v[56:59], v[48:51], v[64:79]
    ds_read_b128 v[32:35], v20
    ds_read_b64_tr_b16 v[40:41], v18 offset:0
    ds_read_b64_tr_b16 v[42:43], v18 offset:1024
    ds_read_b128 v[36:39], v20 offset:4096
    v_mfma_f32_32x32x16_bf16 v[80:95], v[56:59], v[52:55], v[80:95]
    ds_read_b64_tr_b16 v[44:45], v19 offset:0
    ds_read_b64_tr_b16 v[46:47], v19 offset:1024
    v_mfma_f32_32x32x16_bf16 v[96:111], v[60:63], v[48:51], v[96:111]
    v_mfma_f32_32x32x16_bf16 v[112:127], v[60:63], v[52:55], v[112:127]
    v_dot2_f32_bf16 v16, v56, s65, v16
    v_dot2_f32_bf16 v16, v57, s65, v16
    v_dot2_f32_bf16 v16, v58, s65, v16
    v_dot2_f32_bf16 v16, v59, s65, v16
    s_waitcnt lgkmcnt(0)
    v_mfma_f32_32x32x16_bf16 v[64:79], v[40:43], v[32:35], v[64:79]
    ds_read_b128 v[48:51], v21
    ds_read_b64_tr_b16 v[56:57], v18 offset:4096
    ds_read_b64_tr_b16 v[58:59], v18 offset:5120
    ds_read_b128 v[52:55], v21 offset:4096
    v_mfma_f32_32x32x16_bf16 v[80:95], v[40:43], v[36:39], v[80:95]
    ds_read_b64_tr_b16 v[60:61], v19 offset:4096
    ds_read_b64_tr_b16 v[62:63], v19 offset:5120
    v_mfma_f32_32x32x16_bf16 v[96:111], v[44:47], v[32:35], v[96:111]
    v_mfma_f32_32x32x16_bf16 v[112:127], v[44:47], v[36:39], v[112:127]
    v_dot2_f32_bf16 v16, v40, s65, v16
    v_dot2_f32_bf16 v16, v41, s65, v16
    v_dot2_f32_bf16 v16, v42, s65, v16
    v_dot2_f32_bf16 v16, v43, s65, v16
    s_waitcnt lgkmcnt(0)
    s_barrier
    v_mfma_f32_32x32x16_bf16 v[64:79], v[56:59], v[48:51], v[64:79]
    ds_read_b128 v[32:35], v22
    ds_read_b64_tr_b16 v[40:41], v18 offset:16384
    ds_read_b64_tr_b16 v[42:43], v18 offset:17408
    ds_read_b128 v[36:39], v22 offset:4096
    v_mfma_f32_32x32x16_bf16 v[80:95], v[56:59], v[52:55], v[80:95]
    ds_read_b64_tr_b16 v[44:45], v19 offset:16384
    ds_read_b64_tr_b16 v[46:47], v19 offset:17408
    v_mfma_f32_32x32x16_bf16 v[96:111], v[60:63], v[48:51], v[96:111]
    v_mfma_f32_32x32x16_bf16 v[112:127], v[60:63], v[52:55], v[112:127]
    v_dot2_f32_bf16 v16, v56, s65, v16
    v_dot2_f32_bf16 v16, v57, s65, v16
    v_dot2_f32_bf16 v16, v58, s65, v16
    v_dot2_f32_bf16 v16, v59, s65, v16
    s_waitcnt lgkmcnt(0)
    v_mfma_f32_32x32x16_bf16 v[64:79], v[40:43], v[32:35], v[64:79]
    ds_read_b128 v[48:51], v23
    ds_read_b64_tr_b16 v[56:57], v18 offset:20480
    ds_read_b64_tr_b16 v[58:59], v18 offset:21504
    ds_read_b128 v[52:55], v23 offset:4096
    v_mfma_f32_32x32x16_bf16 v[80:95], v[40:43], v[36:39], v[80:95]
    ds_read_b64_tr_b16 v[60:61], v19 offset:20480
    ds_read_b64_tr_b16 v[62:63], v19 offset:21504
    v_mfma_f32_32x32x16_bf16 v[96:111], v[44:47], v[32:35], v[96:111]
    v_xor_b32 v18, 0x8000, v18
    v_xor_b32 v19, 0x8000, v19
    s_sub_u32 s64, s62, s61
    s_mov_b32 s60, s61
    s_mov_b32 s61, s62
    v_add_u32 v20, s64, v20
    v_mfma_f32_32x32x16_bf16 v[112:127], v[44:47], v[36:39], v[112:127]
    v_add_u32 v21, s64, v21
    v_add_u32 v22, s64, v22
    v_add_u32 v23, s64, v23
    s_mov_b32 s62, s63
    s_mov_b32 s63, s60
    s_add_u32 s53, s53, 2
    s_cmp_lt_u32 s53, 16
    v_dot2_f32_bf16 v16, v40, s65, v16
    v_dot2_f32_bf16 v16, v41, s65, v16
    v_dot2_f32_bf16 v16, v42, s65, v16
    v_dot2_f32_bf16 v16, v43, s65, v16
    s_cbranch_scc1 C1_loopQK
    s_waitcnt lgkmcnt(0)
    v_dot2_f32_bf16 v16, v56, s65, v16
    v_dot2_f32_bf16 v16, v57, s65, v16
    v_dot2_f32_bf16 v16, v58, s65, v16
    v_dot2_f32_bf16 v16, v59, s65, v16
    v_mfma_f32_32x32x16_bf16 v[64:79], v[56:59], v[48:51], v[64:79]
    v_mfma_f32_32x32x16_bf16 v[80:95], v[56:59], v[52:55], v[80:95]
    v_mfma_f32_32x32x16_bf16 v[96:111], v[60:63], v[48:51], v[96:111]
    v_mfma_f32_32x32x16_bf16 v[112:127], v[60:63], v[52:55], v[112:127]
    s_branch C1_epi
C1_loopV:
    s_cmp_eq_u32 s53, 2
    s_cbranch_scc0 EPL_52
    s_load_dword s26, s[24:25], 0x0
EPL_52:
    s_waitcnt lgkmcnt(0)
    s_barrier
    v_mfma_f32_32x32x16_bf16 v[64:79], v[48:51], v[56:59], v[64:79]
    ds_read_b128 v[32:35], v20
    ds_read_b64_tr_b16 v[40:41], v18 offset:0
    ds_read_b64_tr_b16 v[42:43], v18 offset:1024
    ds_read_b128 v[36:39], v20 offset:4096
    v_mfma_f32_32x32x16_bf16 v[80:95], v[52:55], v[56:59], v[80:95]
    ds_read_b64_tr_b16 v[44:45], v19 offset:0
    ds_read_b64_tr_b16 v[46:47], v19 offset:1024
    v_mfma_f32_32x32x16_bf16 v[96:111], v[48:51], v[60:63], v[96:111]
    v_mfma_f32_32x32x16_bf16 v[112:127], v[52:55], v[60:63], v[112:127]
    v_dot2_f32_bf16 v16, v56, s65, v16
    v_dot2_f32_bf16 v16, v57, s65, v16
    v_dot2_f32_bf16 v16, v58, s65, v16
    v_dot2_f32_bf16 v16, v59, s65, v16
    s_waitcnt lgkmcnt(0)
    v_mfma_f32_32x32x16_bf16 v[64:79], v[32:35], v[40:43], v[64:79]
    ds_read_b128 v[48:51], v21
    ds_read_b64_tr_b16 v[56:57], v18 offset:4096
    ds_read_b64_tr_b16 v[58:59], v18 offset:5120
    ds_read_b128 v[52:55], v21 offset:4096
    v_mfma_f32_32x32x16_bf16 v[80:95], v[36:39], v[40:43], v[80:95]
    ds_read_b64_tr_b16 v[60:61], v19 offset:4096
    ds_read_b64_tr_b16 v[62:63], v19 offset:5120
    v_mfma_f32_32x32x16_bf16 v[96:111], v[32:35], v[44:47], v[96:111]
    v_mfma_f32_32x32x16_bf16 v[112:127], v[36:39], v[44:47], v[112:127]
    v_dot2_f32_bf16 v16, v40, s65, v16
    v_dot2_f32_bf16 v16, v41, s65, v16
    v_dot2_f32_bf16 v16, v42, s65, v16
    v_dot2_f32_bf16 v16, v43, s65, v16
    s_waitcnt lgkmcnt(0)
    s_barrier
    v_mfma_f32_32x32x16_bf16 v[64:79], v[48:51], v[56:59], v[64:79]
    ds_read_b128 v[32:35], v22
    ds_read_b64_tr_b16 v[40:41], v18 offset:16384
    ds_read_b64_tr_b16 v[42:43], v18 offset:17408
    ds_read_b128 v[36:39], v22 offset:4096
    v_mfma_f32_32x32x16_bf16 v[80:95], v[52:55], v[56:59], v[80:95]
    ds_read_b64_tr_b16 v[44:45], v19 offset:16384
    ds_read_b64_tr_b16 v[46:47], v19 offset:17408
    v_mfma_f32_32x32x16_bf16 v[96:111], v[48:51], v[60:63], v[96:111]
    v_mfma_f32_32x32x16_bf16 v[112:127], v[52:55], v[60:63], v[112:127]
    v_dot2_f32_bf16 v16, v56, s65, v16
    v_dot2_f32_bf16 v16, v57, s65, v16
    v_dot2_f32_bf16 v16, v58, s65, v16
    v_dot2_f32_bf16 v16, v59, s65, v16
    s_waitcnt lgkmcnt(0)
    v_mfma_f32_32x32x16_bf16 v[64:79], v[32:35], v[40:43], v[64:79]
    ds_read_b128 v[48:51], v23
    ds_read_b64_tr_b16 v[56:57], v18 offset:20480
    ds_read_b64_tr_b16 v[58:59], v18 offset:21504
    ds_read_b128 v[52:55], v23 offset:4096
    v_mfma_f32_32x32x16_bf16 v[80:95], v[36:39], v[40:43], v[80:95]
    ds_read_b64_tr_b16 v[60:61], v19 offset:20480
    ds_read_b64_tr_b16 v[62:63], v19 offset:21504
    v_mfma_f32_32x32x16_bf16 v[96:111], v[32:35], v[44:47], v[96:111]
    v_xor_b32 v18, 0x8000, v18
    v_xor_b32 v19, 0x8000, v19
    s_sub_u32 s64, s62, s61
    s_mov_b32 s60, s61
    s_mov_b32 s61, s62
    v_add_u32 v20, s64, v20
    v_mfma_f32_32x32x16_bf16 v[112:127], v[36:39], v[44:47], v[112:127]
    v_add_u32 v21, s64, v21
    v_add_u32 v22, s64, v22
    v_add_u32 v23, s64, v23
    s_mov_b32 s62, s63
    s_mov_b32 s63, s60
    s_add_u32 s53, s53, 2
    s_cmp_lt_u32 s53, 16
    v_dot2_f32_bf16 v16, v40, s65, v16
    v_dot2_f32_bf16 v16, v41, s65, v16
    v_dot2_f32_bf16 v16, v42, s65, v16
    v_dot2_f32_bf16 v16, v43, s65, v16
    s_cbranch_scc1 C1_loopV
    s_waitcnt lgkmcnt(0)
    v_dot2_f32_bf16 v16, v56, s65, v16
    v_dot2_f32_bf16 v16, v57, s65, v16
    v_dot2_f32_bf16 v16, v58, s65, v16
    v_dot2_f32_bf16 v16, v59, s65, v16
    v_mfma_f32_32x32x16_bf16 v[64:79], v[48:51], v[56:59], v[64:79]
    v_mfma_f32_32x32x16_bf16 v[80:95], v[52:55], v[56:59], v[80:95]
    v_mfma_f32_32x32x16_bf16 v[96:111], v[48:51], v[60:63], v[96:111]
    v_mfma_f32_32x32x16_bf16 v[112:127], v[52:55], v[60:63], v[112:127]
C1_epi:
    v_mov_b32 v17, v16
    s_lshl_b32 s55, s52, 7
    s_add_u32 s55, s55, 66560
    v_permlane32_swap_b32 v16, v17
    v_lshl_add_u32 v13, v2, 2, s55
    v_add_f32 v16, v16, v17
    ds_write_b32 v13, v16
    s_lshl_b32 s66, s50, 17
    s_lshl_b32 s64, s50, 7
    s_waitcnt lgkmcnt(0)
    s_add_u32 s26, s26, 0x9e3779b9
    s_barrier
    s_cmp_ge_u32 s44, 8
    s_cbranch_scc1 C1_epiV
    s_lshl_b32 s55, s50, 8
    s_add_u32 s55, s55, 65536
    v_lshl_add_u32 v13, v2, 2, s55
    ds_read2_b32 v[16:17], v13 offset0:0 offset1:128
    ds_read2_b32 v[18:19], v13 offset0:32 offset1:160
    s_lshl_b32 s55, s51, 8
    s_add_u32 s55, s55, 66560
    s_add_u32 s55, s55, s64
    v_lshl_add_u32 v14, v3, 4, s55
    ds_read_b128 v[32:35], v14 offset:0
    ds_read_b128 v[36:39], v14 offset:32
    ds_read_b128 v[40:43], v14 offset:64
    ds_read_b128 v[44:47], v14 offset:96
    v_xor_b32 v14, 128, v14
    ds_read_b128 v[48:51], v14 offset:0
    ds_read_b128 v[52:55], v14 offset:32
    ds_read_b128 v[56:59], v14 offset:64
    ds_read_b128 v[60:63], v14 offset:96
    v_lshlrev_b32 v12, 4, v1
    s_cmp_lt_u32 s44, 4
    s_cselect_b32 s55, 0x3eb8aa3b, 1.0
    s_waitcnt lgkmcnt(0)
    v_mul_f32 v17, s55, v17
    v_mul_f32 v19, s55, v19
    v_pk_fma_f32 v[64:65], v[16:17], v[32:33], v[64:65] op_sel_hi:[0,1,1] neg_lo:[1,0,0] neg_hi:[1,0,0]
    v_pk_fma_f32 v[66:67], v[16:17], v[34:35], v[66:67] op_sel_hi:[0,1,1] neg_lo:[1,0,0] neg_hi:[1,0,0]
    v_pk_fma_f32 v[68:69], v[16:17], v[36:37], v[68:69] op_sel_hi:[0,1,1] neg_lo:[1,0,0] neg_hi:[1,0,0]
    v_pk_fma_f32 v[70:71], v[16:17], v[38:39], v[70:71] op_sel_hi:[0,1,1] neg_lo:[1,0,0] neg_hi:[1,0,0]
    v_pk_fma_f32 v[72:73], v[16:17], v[40:41], v[72:73] op_sel_hi:[0,1,1] neg_lo:[1,0,0] neg_hi:[1,0,0]
    v_pk_fma_f32 v[74:75], v[16:17], v[42:43], v[74:75] op_sel_hi:[0,1,1] neg_lo:[1,0,0] neg_hi:[1,0,0]
    v_pk_fma_f32 v[76:77], v[16:17], v[44:45], v[76:77] op_sel_hi:[0,1,1] neg_lo:[1,0,0] neg_hi:[1,0,0]
    v_pk_fma_f32 v[78:79], v[16:17], v[46:47], v[78:79] op_sel_hi:[0,1,1] neg_lo:[1,0,0] neg_hi:[1,0,0]
    v_pk_mul_f32 v[64:65], v[16:17], v[64:65] op_sel:[1,0] op_sel_hi:[1,1]
    v_pk_mul_f32 v[66:67], v[16:17], v[66:67] op_sel:[1,0] op_sel_hi:[1,1]
    v_pk_mul_f32 v[68:69], v[16:17], v[68:69] op_sel:[1,0] op_sel_hi:[1,1]
    v_pk_mul_f32 v[70:71], v[16:17], v[70:71] op_sel:[1,0] op_sel_hi:[1,1]
    v_pk_mul_f32 v[72:73], v[16:17], v[72:73] op_sel:[1,0] op_sel_hi:[1,1]
    v_pk_mul_f32 v[74:75], v[16:17], v[74:75] op_sel:[1,0] op_sel_hi:[1,1]
    v_pk_mul_f32 v[76:77], v[16:17], v[76:77] op_sel:[1,0] op_sel_hi:[1,1]
    v_pk_mul_f32 v[78:79], v[16:17], v[78:79] op_sel:[1,0] op_sel_hi:[1,1]
    s_xor_b32 s68, s66, 0
    s_add_u32 s68, s68, s67
    s_add_u32 s69, s68, 65536
    v_cvt_pk_bf16_f32 v64, v64, v65
    v_cvt_pk_bf16_f32 v65, v66, v67
    v_cvt_pk_bf16_f32 v66, v68, v69
    v_cvt_pk_bf16_f32 v67, v70, v71
    v_cvt_pk_bf16_f32 v68, v72, v73
    v_cvt_pk_bf16_f32 v69, v74, v75
    v_cvt_pk_bf16_f32 v70, v76, v77
    v_cvt_pk_bf16_f32 v71, v78, v79
    buffer_store_dwordx4 v[64:67], v12, s[28:31], s68 offen offset:0 sc1
    buffer_store_dwordx4 v[68:71], v12, s[28:31], s69 offen offset:0 sc1
    v_pk_fma_f32 v[80:81], v[18:19], v[32:33], v[80:81] op_sel_hi:[0,1,1] neg_lo:[1,0,0] neg_hi:[1,0,0]
    v_pk_fma_f32 v[82:83], v[18:19], v[34:35], v[82:83] op_sel_hi:[0,1,1] neg_lo:[1,0,0] neg_hi:[1,0,0]
    v_pk_fma_f32 v[84:85], v[18:19], v[36:37], v[84:85] op_sel_hi:[0,1,1] neg_lo:[1,0,0] neg_hi:[1,0,0]
    v_pk_fma_f32 v[86:87], v[18:19], v[38:39], v[86:87] op_sel_hi:[0,1,1] neg_lo:[1,0,0] neg_hi:[1,0,0]
    v_pk_fma_f32 v[88:89], v[18:19], v[40:41], v[88:89] op_sel_hi:[0,1,1] neg_lo:[1,0,0] neg_hi:[1,0,0]
    v_pk_fma_f32 v[90:91], v[18:19], v[42:43], v[90:91] op_sel_hi:[0,1,1] neg_lo:[1,0,0] neg_hi:[1,0,0]
    v_pk_fma_f32 v[92:93], v[18:19], v[44:45], v[92:93] op_sel_hi:[0,1,1] neg_lo:[1,0,0] neg_hi:[1,0,0]
    v_pk_fma_f32 v[94:95], v[18:19], v[46:47], v[94:95] op_sel_hi:[0,1,1] neg_lo:[1,0,0] neg_hi:[1,0,0]
    v_pk_mul_f32 v[80:81], v[18:19], v[80:81] op_sel:[1,0] op_sel_hi:[1,1]
    v_pk_mul_f32 v[82:83], v[18:19], v[82:83] op_sel:[1,0] op_sel_hi:[1,1]
    v_pk_mul_f32 v[84:85], v[18:19], v[84:85] op_sel:[1,0] op_sel_hi:[1,1]
    v_pk_mul_f32 v[86:87], v[18:19], v[86:87] op_sel:[1,0] op_sel_hi:[1,1]
    v_pk_mul_f32 v[88:89], v[18:19], v[88:89] op_sel:[1,0] op_sel_hi:[1,1]
    v_pk_mul_f32 v[90:91], v[18:19], v[90:91] op_sel:[1,0] op_sel_hi:[1,1]
    v_pk_mul_f32 v[92:93], v[18:19], v[92:93] op_sel:[1,0] op_sel_hi:[1,1]
    v_pk_mul_f32 v[94:95], v[18:19], v[94:95] op_sel:[1,0] op_sel_hi:[1,1]
    s_xor_b32 s68, s66, 0
    s_add_u32 s68, s68, s67
    s_add_u32 s69, s68, 65536
    v_cvt_pk_bf16_f32 v80, v80, v81
    v_cvt_pk_bf16_f32 v81, v82, v83
    v_cvt_pk_bf16_f32 v82, v84, v85
    v_cvt_pk_bf16_f32 v83, v86, v87
    v_cvt_pk_bf16_f32 v84, v88, v89
    v_cvt_pk_bf16_f32 v85, v90, v91
    v_cvt_pk_bf16_f32 v86, v92, v93
    v_cvt_pk_bf16_f32 v87, v94, v95
    buffer_store_dwordx4 v[80:83], v12, s[28:31], s68 offen offset:1024 sc1
    buffer_store_dwordx4 v[84:87], v12, s[28:31], s69 offen offset:1024 sc1
    v_pk_fma_f32 v[96:97], v[16:17], v[48:49], v[96:97] op_sel_hi:[0,1,1] neg_lo:[1,0,0] neg_hi:[1,0,0]
    v_pk_fma_f32 v[98:99], v[16:17], v[50:51], v[98:99] op_sel_hi:[0,1,1] neg_lo:[1,0,0] neg_hi:[1,0,0]
    v_pk_fma_f32 v[100:101], v[16:17], v[52:53], v[100:101] op_sel_hi:[0,1,1] neg_lo:[1,0,0] neg_hi:[1,0,0]
    v_pk_fma_f32 v[102:103], v[16:17], v[54:55], v[102:103] op_sel_hi:[0,1,1] neg_lo:[1,0,0] neg_hi:[1,0,0]
    v_pk_fma_f32 v[104:105], v[16:17], v[56:57], v[104:105] op_sel_hi:[0,1,1] neg_lo:[1,0,0] neg_hi:[1,0,0]
    v_pk_fma_f32 v[106:107], v[16:17], v[58:59], v[106:107] op_sel_hi:[0,1,1] neg_lo:[1,0,0] neg_hi:[1,0,0]
    v_pk_fma_f32 v[108:109], v[16:17], v[60:61], v[108:109] op_sel_hi:[0,1,1] neg_lo:[1,0,0] neg_hi:[1,0,0]
    v_pk_fma_f32 v[110:111], v[16:17], v[62:63], v[110:111] op_sel_hi:[0,1,1] neg_lo:[1,0,0] neg_hi:[1,0,0]
    v_pk_mul_f32 v[96:97], v[16:17], v[96:97] op_sel:[1,0] op_sel_hi:[1,1]
    v_pk_mul_f32 v[98:99], v[16:17], v[98:99] op_sel:[1,0] op_sel_hi:[1,1]
    v_pk_mul_f32 v[100:101], v[16:17], v[100:101] op_sel:[1,0] op_sel_hi:[1,1]
    v_pk_mul_f32 v[102:103], v[16:17], v[102:103] op_sel:[1,0] op_sel_hi:[1,1]
    v_pk_mul_f32 v[104:105], v[16:17], v[104:105] op_sel:[1,0] op_sel_hi:[1,1]
    v_pk_mul_f32 v[106:107], v[16:17], v[106:107] op_sel:[1,0] op_sel_hi:[1,1]
    v_pk_mul_f32 v[108:109], v[16:17], v[108:109] op_sel:[1,0] op_sel_hi:[1,1]
    v_pk_mul_f32 v[110:111], v[16:17], v[110:111] op_sel:[1,0] op_sel_hi:[1,1]
    s_xor_b32 s68, s66, 131072
    s_add_u32 s68, s68, s67
    s_add_u32 s69, s68, 65536
    v_cvt_pk_bf16_f32 v96, v96, v97
    v_cvt_pk_bf16_f32 v97, v98, v99
    v_cvt_pk_bf16_f32 v98, v100, v101
    v_cvt_pk_bf16_f32 v99, v102, v103
    v_cvt_pk_bf16_f32 v100, v104, v105
    v_cvt_pk_bf16_f32 v101, v106, v107
    v_cvt_pk_bf16_f32 v102, v108, v109
    v_cvt_pk_bf16_f32 v103, v110, v111
    buffer_store_dwordx4 v[96:99], v12, s[28:31], s68 offen offset:0 sc1
    buffer_store_dwordx4 v[100:103], v12, s[28:31], s69 offen offset:0 sc1
    v_pk_fma_f32 v[112:113], v[18:19], v[48:49], v[112:113] op_sel_hi:[0,1,1] neg_lo:[1,0,0] neg_hi:[1,0,0]
    v_pk_fma_f32 v[114:115], v[18:19], v[50:51], v[114:115] op_sel_hi:[0,1,1] neg_lo:[1,0,0] neg_hi:[1,0,0]
    v_pk_fma_f32 v[116:117], v[18:19], v[52:53], v[116:117] op_sel_hi:[0,1,1] neg_lo:[1,0,0] neg_hi:[1,0,0]
    v_pk_fma_f32 v[118:119], v[18:19], v[54:55], v[118:119] op_sel_hi:[0,1,1] neg_lo:[1,0,0] neg_hi:[1,0,0]
    v_pk_fma_f32 v[120:121], v[18:19], v[56:57], v[120:121] op_sel_hi:[0,1,1] neg_lo:[1,0,0] neg_hi:[1,0,0]
    v_pk_fma_f32 v[122:123], v[18:19], v[58:59], v[122:123] op_sel_hi:[0,1,1] neg_lo:[1,0,0] neg_hi:[1,0,0]
    v_pk_fma_f32 v[124:125], v[18:19], v[60:61], v[124:125] op_sel_hi:[0,1,1] neg_lo:[1,0,0] neg_hi:[1,0,0]
    v_pk_fma_f32 v[126:127], v[18:19], v[62:63], v[126:127] op_sel_hi:[0,1,1] neg_lo:[1,0,0] neg_hi:[1,0,0]
    v_pk_mul_f32 v[112:113], v[18:19], v[112:113] op_sel:[1,0] op_sel_hi:[1,1]
    v_pk_mul_f32 v[114:115], v[18:19], v[114:115] op_sel:[1,0] op_sel_hi:[1,1]
    v_pk_mul_f32 v[116:117], v[18:19], v[116:117] op_sel:[1,0] op_sel_hi:[1,1]
    v_pk_mul_f32 v[118:119], v[18:19], v[118:119] op_sel:[1,0] op_sel_hi:[1,1]
    v_pk_mul_f32 v[120:121], v[18:19], v[120:121] op_sel:[1,0] op_sel_hi:[1,1]
    v_pk_mul_f32 v[122:123], v[18:19], v[122:123] op_sel:[1,0] op_sel_hi:[1,1]
    v_pk_mul_f32 v[124:125], v[18:19], v[124:125] op_sel:[1,0] op_sel_hi:[1,1]
    v_pk_mul_f32 v[126:127], v[18:19], v[126:127] op_sel:[1,0] op_sel_hi:[1,1]
    s_xor_b32 s68, s66, 131072
    s_add_u32 s68, s68, s67
    s_add_u32 s69, s68, 65536
    v_cvt_pk_bf16_f32 v112, v112, v113
    v_cvt_pk_bf16_f32 v113, v114, v115
    v_cvt_pk_bf16_f32 v114, v116, v117
    v_cvt_pk_bf16_f32 v115, v118, v119
    v_cvt_pk_bf16_f32 v116, v120, v121
    v_cvt_pk_bf16_f32 v117, v122, v123
    v_cvt_pk_bf16_f32 v118, v124, v125
    v_cvt_pk_bf16_f32 v119, v126, v127
    buffer_store_dwordx4 v[112:115], v12, s[28:31], s68 offen offset:1024 sc1
    buffer_store_dwordx4 v[116:119], v12, s[28:31], s69 offen offset:1024 sc1
    s_branch C1_done
C1_epiV:
    v_xor_b32 v13, 128, v13
    ds_read_b32 v17, v13
    s_lshl_b32 s55, s50, 8
    s_add_u32 s55, s55, 65536
    v_lshl_add_u32 v14, v3, 4, s55
    ds_read_b128 v[32:35], v14 offset:0
    ds_read_b128 v[36:39], v14 offset:32
    ds_read_b128 v[40:43], v14 offset:64
    ds_read_b128 v[44:47], v14 offset:96
    ds_read_b128 v[48:51], v14 offset:512
    ds_read_b128 v[52:55], v14 offset:544
    ds_read_b128 v[56:59], v14 offset:576
    ds_read_b128 v[60:63], v14 offset:608
    v_bfe_u32 v12, v1, 4, 1
    v_lshlrev_b32 v12, 16, v12
    v_lshl_add_u32 v12, v3, 8, v12
    v_and_b32 v13, 15, v1
    v_lshl_add_u32 v12, v13, 4, v12
    s_waitcnt lgkmcnt(0)
    v_pk_fma_f32 v[64:65], v[16:17], v[32:33], v[64:65] op_sel_hi:[0,1,1] neg_lo:[1,0,0] neg_hi:[1,0,0]
    v_pk_fma_f32 v[66:67], v[16:17], v[34:35], v[66:67] op_sel_hi:[0,1,1] neg_lo:[1,0,0] neg_hi:[1,0,0]
    v_pk_fma_f32 v[68:69], v[16:17], v[36:37], v[68:69] op_sel_hi:[0,1,1] neg_lo:[1,0,0] neg_hi:[1,0,0]
    v_pk_fma_f32 v[70:71], v[16:17], v[38:39], v[70:71] op_sel_hi:[0,1,1] neg_lo:[1,0,0] neg_hi:[1,0,0]
    v_pk_fma_f32 v[72:73], v[16:17], v[40:41], v[72:73] op_sel_hi:[0,1,1] neg_lo:[1,0,0] neg_hi:[1,0,0]
    v_pk_fma_f32 v[74:75], v[16:17], v[42:43], v[74:75] op_sel_hi:[0,1,1] neg_lo:[1,0,0] neg_hi:[1,0,0]
    v_pk_fma_f32 v[76:77], v[16:17], v[44:45], v[76:77] op_sel_hi:[0,1,1] neg_lo:[1,0,0] neg_hi:[1,0,0]
    v_pk_fma_f32 v[78:79], v[16:17], v[46:47], v[78:79] op_sel_hi:[0,1,1] neg_lo:[1,0,0] neg_hi:[1,0,0]
    v_pk_mul_f32 v[64:65], v[48:49], v[64:65]
    v_pk_mul_f32 v[66:67], v[50:51], v[66:67]
    v_pk_mul_f32 v[68:69], v[52:53], v[68:69]
    v_pk_mul_f32 v[70:71], v[54:55], v[70:71]
    v_pk_mul_f32 v[72:73], v[56:57], v[72:73]
    v_pk_mul_f32 v[74:75], v[58:59], v[74:75]
    v_pk_mul_f32 v[76:77], v[60:61], v[76:77]
    v_pk_mul_f32 v[78:79], v[62:63], v[78:79]
    s_xor_b32 s68, s66, 0
    s_add_u32 s68, s68, s67
    v_cvt_pk_bf16_f32 v64, v64, v65
    v_cvt_pk_bf16_f32 v65, v66, v67
    v_cvt_pk_bf16_f32 v66, v68, v69
    v_cvt_pk_bf16_f32 v67, v70, v71
    v_cvt_pk_bf16_f32 v68, v72, v73
    v_cvt_pk_bf16_f32 v69, v74, v75
    v_cvt_pk_bf16_f32 v70, v76, v77
    v_cvt_pk_bf16_f32 v71, v78, v79
    buffer_store_dwordx4 v[64:67], v12, s[28:31], s68 offen offset:0 sc1
    buffer_store_dwordx4 v[68:71], v12, s[28:31], s68 offen offset:512 sc1
    v_pk_fma_f32 v[96:97], v[16:17], v[32:33], v[96:97] op_sel:[1,0,0] op_sel_hi:[1,1,1] neg_lo:[1,0,0] neg_hi:[1,0,0]
    v_pk_fma_f32 v[98:99], v[16:17], v[34:35], v[98:99] op_sel:[1,0,0] op_sel_hi:[1,1,1] neg_lo:[1,0,0] neg_hi:[1,0,0]
    v_pk_fma_f32 v[100:101], v[16:17], v[36:37], v[100:101] op_sel:[1,0,0] op_sel_hi:[1,1,1] neg_lo:[1,0,0] neg_hi:[1,0,0]
    v_pk_fma_f32 v[102:103], v[16:17], v[38:39], v[102:103] op_sel:[1,0,0] op_sel_hi:[1,1,1] neg_lo:[1,0,0] neg_hi:[1,0,0]
    v_pk_fma_f32 v[104:105], v[16:17], v[40:41], v[104:105] op_sel:[1,0,0] op_sel_hi:[1,1,1] neg_lo:[1,0,0] neg_hi:[1,0,0]
    v_pk_fma_f32 v[106:107], v[16:17], v[42:43], v[106:107] op_sel:[1,0,0] op_sel_hi:[1,1,1] neg_lo:[1,0,0] neg_hi:[1,0,0]
    v_pk_fma_f32 v[108:109], v[16:17], v[44:45], v[108:109] op_sel:[1,0,0] op_sel_hi:[1,1,1] neg_lo:[1,0,0] neg_hi:[1,0,0]
    v_pk_fma_f32 v[110:111], v[16:17], v[46:47], v[110:111] op_sel:[1,0,0] op_sel_hi:[1,1,1] neg_lo:[1,0,0] neg_hi:[1,0,0]
    v_pk_mul_f32 v[96:97], v[48:49], v[96:97]
    v_pk_mul_f32 v[98:99], v[50:51], v[98:99]
    v_pk_mul_f32 v[100:101], v[52:53], v[100:101]
    v_pk_mul_f32 v[102:103], v[54:55], v[102:103]
    v_pk_mul_f32 v[104:105], v[56:57], v[104:105]
    v_pk_mul_f32 v[106:107], v[58:59], v[106:107]
    v_pk_mul_f32 v[108:109], v[60:61], v[108:109]
    v_pk_mul_f32 v[110:111], v[62:63], v[110:111]
    ds_read_b128 v[32:35], v14 offset:128
    ds_read_b128 v[36:39], v14 offset:160
    ds_read_b128 v[40:43], v14 offset:192
    ds_read_b128 v[44:47], v14 offset:224
    ds_read_b128 v[48:51], v14 offset:640
    ds_read_b128 v[52:55], v14 offset:672
    ds_read_b128 v[56:59], v14 offset:704
    ds_read_b128 v[60:63], v14 offset:736
    s_xor_b32 s68, s66, 131072
    s_add_u32 s68, s68, s67
    v_cvt_pk_bf16_f32 v96, v96, v97
    v_cvt_pk_bf16_f32 v97, v98, v99
    v_cvt_pk_bf16_f32 v98, v100, v101
    v_cvt_pk_bf16_f32 v99, v102, v103
    v_cvt_pk_bf16_f32 v100, v104, v105
    v_cvt_pk_bf16_f32 v101, v106, v107
    v_cvt_pk_bf16_f32 v102, v108, v109
    v_cvt_pk_bf16_f32 v103, v110, v111
    buffer_store_dwordx4 v[96:99], v12, s[28:31], s68 offen offset:0 sc1
    buffer_store_dwordx4 v[100:103], v12, s[28:31], s68 offen offset:512 sc1
    s_waitcnt lgkmcnt(0)
    v_pk_fma_f32 v[80:81], v[16:17], v[32:33], v[80:81] op_sel_hi:[0,1,1] neg_lo:[1,0,0] neg_hi:[1,0,0]
    v_pk_fma_f32 v[82:83], v[16:17], v[34:35], v[82:83] op_sel_hi:[0,1,1] neg_lo:[1,0,0] neg_hi:[1,0,0]
    v_pk_fma_f32 v[84:85], v[16:17], v[36:37], v[84:85] op_sel_hi:[0,1,1] neg_lo:[1,0,0] neg_hi:[1,0,0]
    v_pk_fma_f32 v[86:87], v[16:17], v[38:39], v[86:87] op_sel_hi:[0,1,1] neg_lo:[1,0,0] neg_hi:[1,0,0]
    v_pk_fma_f32 v[88:89], v[16:17], v[40:41], v[88:89] op_sel_hi:[0,1,1] neg_lo:[1,0,0] neg_hi:[1,0,0]
    v_pk_fma_f32 v[90:91], v[16:17], v[42:43], v[90:91] op_sel_hi:[0,1,1] neg_lo:[1,0,0] neg_hi:[1,0,0]
    v_pk_fma_f32 v[92:93], v[16:17], v[44:45], v[92:93] op_sel_hi:[0,1,1] neg_lo:[1,0,0] neg_hi:[1,0,0]
    v_pk_fma_f32 v[94:95], v[16:17], v[46:47], v[94:95] op_sel_hi:[0,1,1] neg_lo:[1,0,0] neg_hi:[1,0,0]
    v_pk_mul_f32 v[80:81], v[48:49], v[80:81]
    v_pk_mul_f32 v[82:83], v[50:51], v[82:83]
    v_pk_mul_f32 v[84:85], v[52:53], v[84:85]
    v_pk_mul_f32 v[86:87], v[54:55], v[86:87]
    v_pk_mul_f32 v[88:89], v[56:57], v[88:89]
    v_pk_mul_f32 v[90:91], v[58:59], v[90:91]
    v_pk_mul_f32 v[92:93], v[60:61], v[92:93]
    v_pk_mul_f32 v[94:95], v[62:63], v[94:95]
    s_xor_b32 s68, s66, 0
    s_add_u32 s68, s68, s67
    v_cvt_pk_bf16_f32 v80, v80, v81
    v_cvt_pk_bf16_f32 v81, v82, v83
    v_cvt_pk_bf16_f32 v82, v84, v85
    v_cvt_pk_bf16_f32 v83, v86, v87
    v_cvt_pk_bf16_f32 v84, v88, v89
    v_cvt_pk_bf16_f32 v85, v90, v91
    v_cvt_pk_bf16_f32 v86, v92, v93
    v_cvt_pk_bf16_f32 v87, v94, v95
    buffer_store_dwordx4 v[80:83], v12, s[28:31], s68 offen offset:1024 sc1
    buffer_store_dwordx4 v[84:87], v12, s[28:31], s68 offen offset:1536 sc1
    v_pk_fma_f32 v[112:113], v[16:17], v[32:33], v[112:113] op_sel:[1,0,0] op_sel_hi:[1,1,1] neg_lo:[1,0,0] neg_hi:[1,0,0]
    v_pk_fma_f32 v[114:115], v[16:17], v[34:35], v[114:115] op_sel:[1,0,0] op_sel_hi:[1,1,1] neg_lo:[1,0,0] neg_hi:[1,0,0]
    v_pk_fma_f32 v[116:117], v[16:17], v[36:37], v[116:117] op_sel:[1,0,0] op_sel_hi:[1,1,1] neg_lo:[1,0,0] neg_hi:[1,0,0]
    v_pk_fma_f32 v[118:119], v[16:17], v[38:39], v[118:119] op_sel:[1,0,0] op_sel_hi:[1,1,1] neg_lo:[1,0,0] neg_hi:[1,0,0]
    v_pk_fma_f32 v[120:121], v[16:17], v[40:41], v[120:121] op_sel:[1,0,0] op_sel_hi:[1,1,1] neg_lo:[1,0,0] neg_hi:[1,0,0]
    v_pk_fma_f32 v[122:123], v[16:17], v[42:43], v[122:123] op_sel:[1,0,0] op_sel_hi:[1,1,1] neg_lo:[1,0,0] neg_hi:[1,0,0]
    v_pk_fma_f32 v[124:125], v[16:17], v[44:45], v[124:125] op_sel:[1,0,0] op_sel_hi:[1,1,1] neg_lo:[1,0,0] neg_hi:[1,0,0]
    v_pk_fma_f32 v[126:127], v[16:17], v[46:47], v[126:127] op_sel:[1,0,0] op_sel_hi:[1,1,1] neg_lo:[1,0,0] neg_hi:[1,0,0]
    v_pk_mul_f32 v[112:113], v[48:49], v[112:113]
    v_pk_mul_f32 v[114:115], v[50:51], v[114:115]
    v_pk_mul_f32 v[116:117], v[52:53], v[116:117]
    v_pk_mul_f32 v[118:119], v[54:55], v[118:119]
    v_pk_mul_f32 v[120:121], v[56:57], v[120:121]
    v_pk_mul_f32 v[122:123], v[58:59], v[122:123]
    v_pk_mul_f32 v[124:125], v[60:61], v[124:125]
    v_pk_mul_f32 v[126:127], v[62:63], v[126:127]
    s_xor_b32 s68, s66, 131072
    s_add_u32 s68, s68, s67
    v_cvt_pk_bf16_f32 v112, v112, v113
    v_cvt_pk_bf16_f32 v113, v114, v115
    v_cvt_pk_bf16_f32 v114, v116, v117
    v_cvt_pk_bf16_f32 v115, v118, v119
    v_cvt_pk_bf16_f32 v116, v120, v121
    v_cvt_pk_bf16_f32 v117, v122, v123
    v_cvt_pk_bf16_f32 v118, v124, v125
    v_cvt_pk_bf16_f32 v119, v126, v127
    buffer_store_dwordx4 v[112:115], v12, s[28:31], s68 offen offset:1024 sc1
    buffer_store_dwordx4 v[116:119], v12, s[28:31], s68 offen offset:1536 sc1
C1_done:
    s_cmp_eq_u32 s49, 1
    s_cbranch_scc0 C2_start
    v_mov_b32 v12, s26
    v_mov_b32 v13, 0
    s_waitcnt vmcnt(0)
    buffer_store_dword v12, v13, s[28:31], s58 offen sc1
    s_barrier
    s_branch C3_start
CN_entry:
    s_load_dword s26, s[24:25], 0x0
    v_lshrrev_b32 v14, 3, v4
    v_lshlrev_b32 v14, 18, v14
    v_lshl_add_u32 v14, v15, 7, v14
    v_and_b32 v4, 7, v1
    v_lshl_add_u32 v14, v4, 4, v14
    v_lshlrev_b32 v15, 3, v15
    s_lshl_b32 s61, s59, 6
    s_add_u32 s61, s61, 0x8000
    s_mov_b32 s62, 0x3b000000
    s_mov_b32 s63, 0xffff0000
    s_mov_b32 s64, 0x3f803f80
    s_lshl_b32 s60, s59, 10
    s_add_u32 s60, s60, 0x700000
    v_mov_b32 v4, 0
    v_mov_b32 v5, 0
    s_waitcnt vmcnt(4)
    v_dot2_f32_bf16 v4, v32, s64, v4
    v_dot2_f32_bf16 v5, v32, v32, v5
    v_dot2_f32_bf16 v4, v33, s64, v4
    v_dot2_f32_bf16 v5, v33, v33, v5
    v_dot2_f32_bf16 v4, v34, s64, v4
    v_dot2_f32_bf16 v5, v34, v34, v5
    v_dot2_f32_bf16 v4, v35, s64, v4
    v_dot2_f32_bf16 v5, v35, v35, v5
    v_dot2_f32_bf16 v4, v36, s64, v4
    v_dot2_f32_bf16 v5, v36, v36, v5
    v_dot2_f32_bf16 v4, v37, s64, v4
    v_dot2_f32_bf16 v5, v37, v37, v5
    v_dot2_f32_bf16 v4, v38, s64, v4
    v_dot2_f32_bf16 v5, v38, v38, v5
    v_dot2_f32_bf16 v4, v39, s64, v4
    v_dot2_f32_bf16 v5, v39, v39, v5
    v_dot2_f32_bf16 v4, v40, s64, v4
    v_dot2_f32_bf16 v5, v40, v40, v5
    v_dot2_f32_bf16 v4, v41, s64, v4
    v_dot2_f32_bf16 v5, v41, v41, v5
    v_dot2_f32_bf16 v4, v42, s64, v4
    v_dot2_f32_bf16 v5, v42, v42, v5
    v_dot2_f32_bf16 v4, v43, s64, v4
    v_dot2_f32_bf16 v5, v43, v43, v5
    v_dot2_f32_bf16 v4, v44, s64, v4
    v_dot2_f32_bf16 v5, v44, v44, v5
    v_dot2_f32_bf16 v4, v45, s64, v4
    v_dot2_f32_bf16 v5, v45, v45, v5
    v_dot2_f32_bf16 v4, v46, s64, v4
    v_dot2_f32_bf16 v5, v46, v46, v5
    v_dot2_f32_bf16 v4, v47, s64, v4
    v_dot2_f32_bf16 v5, v47, v47, v5
    s_nop 2
    v_add_f32_dpp v4, v4, v4 row_ror:8 row_mask:0xf bank_mask:0xf
    v_add_f32_dpp v5, v5, v5 row_ror:8 row_mask:0xf bank_mask:0xf
    s_nop 0
    v_add_f32_dpp v4, v4, v4 row_ror:4 row_mask:0xf bank_mask:0xf
    v_add_f32_dpp v5, v5, v5 row_ror:4 row_mask:0xf bank_mask:0xf
    s_nop 0
    v_add_f32_dpp v4, v4, v4 row_ror:2 row_mask:0xf bank_mask:0xf
    v_add_f32_dpp v5, v5, v5 row_ror:2 row_mask:0xf bank_mask:0xf
    s_nop 0
    v_add_f32_dpp v4, v4, v4 row_ror:1 row_mask:0xf bank_mask:0xf
    v_add_f32_dpp v5, v5, v5 row_ror:1 row_mask:0xf bank_mask:0xf
    s_nop 0
    v_mul_f32 v4, s62, v4
    v_mul_f32 v6, v4, v4
    v_fma_f32 v7, v5, s62, -v6
    v_max_f32 v7, 0, v7
    v_add_f32 v5, 0x3727c5ac, v7
    v_rsq_f32 v5, v5
    s_nop 0
    buffer_store_dwordx2 v[4:5], v15, s[28:31], s61 offen offset:0 sc1
    v_mul_f32 v6, v5, v5
    v_mul_f32 v7, v7, v6
    v_add_f32 v7, 0x3727c5ac, v7
    v_rsq_f32 v7, v7
    s_nop 0
    v_mul_f32 v6, v5, v7
    v_mul_f32 v8, v4, v6
    v_sub_f32 v8, 0, v8
    v_lshlrev_b32 v10, 16, v32
    v_and_b32 v11, s63, v32
    v_pk_fma_f32 v[10:11], v[10:11], v[6:7], v[8:9] op_sel_hi:[1,0,0]
    v_cvt_pk_bf16_f32 v32, v10, v11
    v_lshlrev_b32 v12, 16, v33
    v_and_b32 v13, s63, v33
    v_pk_fma_f32 v[12:13], v[12:13], v[6:7], v[8:9] op_sel_hi:[1,0,0]
    v_cvt_pk_bf16_f32 v33, v12, v13
    v_lshlrev_b32 v10, 16, v34
    v_and_b32 v11, s63, v34
    v_pk_fma_f32 v[10:11], v[10:11], v[6:7], v[8:9] op_sel_hi:[1,0,0]
    v_cvt_pk_bf16_f32 v34, v10, v11
    v_lshlrev_b32 v12, 16, v35
    v_and_b32 v13, s63, v35
    v_pk_fma_f32 v[12:13], v[12:13], v[6:7], v[8:9] op_sel_hi:[1,0,0]
    v_cvt_pk_bf16_f32 v35, v12, v13
    buffer_store_dwordx4 v[32:35], v14, s[28:31], s60 offen offset:0 sc1
    s_add_u32 s60, s60, 524288
    v_lshlrev_b32 v10, 16, v36
    v_and_b32 v11, s63, v36
    v_pk_fma_f32 v[10:11], v[10:11], v[6:7], v[8:9] op_sel_hi:[1,0,0]
    v_cvt_pk_bf16_f32 v36, v10, v11
    v_lshlrev_b32 v12, 16, v37
    v_and_b32 v13, s63, v37
    v_pk_fma_f32 v[12:13], v[12:13], v[6:7], v[8:9] op_sel_hi:[1,0,0]
    v_cvt_pk_bf16_f32 v37, v12, v13
    v_lshlrev_b32 v10, 16, v38
    v_and_b32 v11, s63, v38
    v_pk_fma_f32 v[10:11], v[10:11], v[6:7], v[8:9] op_sel_hi:[1,0,0]
    v_cvt_pk_bf16_f32 v38, v10, v11
    v_lshlrev_b32 v12, 16, v39
    v_and_b32 v13, s63, v39
    v_pk_fma_f32 v[12:13], v[12:13], v[6:7], v[8:9] op_sel_hi:[1,0,0]
    v_cvt_pk_bf16_f32 v39, v12, v13
    buffer_store_dwordx4 v[36:39], v14, s[28:31], s60 offen offset:0 sc1
    s_add_u32 s60, s60, 524288
    v_lshlrev_b32 v10, 16, v40
    v_and_b32 v11, s63, v40
    v_pk_fma_f32 v[10:11], v[10:11], v[6:7], v[8:9] op_sel_hi:[1,0,0]
    v_cvt_pk_bf16_f32 v40, v10, v11
    v_lshlrev_b32 v12, 16, v41
    v_and_b32 v13, s63, v41
    v_pk_fma_f32 v[12:13], v[12:13], v[6:7], v[8:9] op_sel_hi:[1,0,0]
    v_cvt_pk_bf16_f32 v41, v12, v13
    v_lshlrev_b32 v10, 16, v42
    v_and_b32 v11, s63, v42
    v_pk_fma_f32 v[10:11], v[10:11], v[6:7], v[8:9] op_sel_hi:[1,0,0]
    v_cvt_pk_bf16_f32 v42, v10, v11
    v_lshlrev_b32 v12, 16, v43
    v_and_b32 v13, s63, v43
    v_pk_fma_f32 v[12:13], v[12:13], v[6:7], v[8:9] op_sel_hi:[1,0,0]
    v_cvt_pk_bf16_f32 v43, v12, v13
    buffer_store_dwordx4 v[40:43], v14, s[28:31], s60 offen offset:0 sc1
    s_add_u32 s60, s60, 524288
    v_lshlrev_b32 v10, 16, v44
    v_and_b32 v11, s63, v44
    v_pk_fma_f32 v[10:11], v[10:11], v[6:7], v[8:9] op_sel_hi:[1,0,0]
    v_cvt_pk_bf16_f32 v44, v10, v11
    v_lshlrev_b32 v12, 16, v45
    v_and_b32 v13, s63, v45
    v_pk_fma_f32 v[12:13], v[12:13], v[6:7], v[8:9] op_sel_hi:[1,0,0]
    v_cvt_pk_bf16_f32 v45, v12, v13
    v_lshlrev_b32 v10, 16, v46
    v_and_b32 v11, s63, v46
    v_pk_fma_f32 v[10:11], v[10:11], v[6:7], v[8:9] op_sel_hi:[1,0,0]
    v_cvt_pk_bf16_f32 v46, v10, v11
    v_lshlrev_b32 v12, 16, v47
    v_and_b32 v13, s63, v47
    v_pk_fma_f32 v[12:13], v[12:13], v[6:7], v[8:9] op_sel_hi:[1,0,0]
    v_cvt_pk_bf16_f32 v47, v12, v13
    buffer_store_dwordx4 v[44:47], v14, s[28:31], s60 offen offset:0 sc1
    s_add_u32 s60, s60, 524288
    s_lshl_b32 s60, s59, 10
    s_add_u32 s60, s60, 0x700000
    v_mov_b32 v4, 0
    v_mov_b32 v5, 0
    s_waitcnt vmcnt(5)
    v_dot2_f32_bf16 v4, v48, s64, v4
    v_dot2_f32_bf16 v5, v48, v48, v5
    v_dot2_f32_bf16 v4, v49, s64, v4
    v_dot2_f32_bf16 v5, v49, v49, v5
    v_dot2_f32_bf16 v4, v50, s64, v4
    v_dot2_f32_bf16 v5, v50, v50, v5
    v_dot2_f32_bf16 v4, v51, s64, v4
    v_dot2_f32_bf16 v5, v51, v51, v5
    v_dot2_f32_bf16 v4, v52, s64, v4
    v_dot2_f32_bf16 v5, v52, v52, v5
    v_dot2_f32_bf16 v4, v53, s64, v4
    v_dot2_f32_bf16 v5, v53, v53, v5
    v_dot2_f32_bf16 v4, v54, s64, v4
    v_dot2_f32_bf16 v5, v54, v54, v5
    v_dot2_f32_bf16 v4, v55, s64, v4
    v_dot2_f32_bf16 v5, v55, v55, v5
    v_dot2_f32_bf16 v4, v56, s64, v4
    v_dot2_f32_bf16 v5, v56, v56, v5
    v_dot2_f32_bf16 v4, v57, s64, v4
    v_dot2_f32_bf16 v5, v57, v57, v5
    v_dot2_f32_bf16 v4, v58, s64, v4
    v_dot2_f32_bf16 v5, v58, v58, v5
    v_dot2_f32_bf16 v4, v59, s64, v4
    v_dot2_f32_bf16 v5, v59, v59, v5
    v_dot2_f32_bf16 v4, v60, s64, v4
    v_dot2_f32_bf16 v5, v60, v60, v5
    v_dot2_f32_bf16 v4, v61, s64, v4
    v_dot2_f32_bf16 v5, v61, v61, v5
    v_dot2_f32_bf16 v4, v62, s64, v4
    v_dot2_f32_bf16 v5, v62, v62, v5
    v_dot2_f32_bf16 v4, v63, s64, v4
    v_dot2_f32_bf16 v5, v63, v63, v5
    s_nop 2
    v_add_f32_dpp v4, v4, v4 row_ror:8 row_mask:0xf bank_mask:0xf
    v_add_f32_dpp v5, v5, v5 row_ror:8 row_mask:0xf bank_mask:0xf
    s_nop 0
    v_add_f32_dpp v4, v4, v4 row_ror:4 row_mask:0xf bank_mask:0xf
    v_add_f32_dpp v5, v5, v5 row_ror:4 row_mask:0xf bank_mask:0xf
    s_nop 0
    v_add_f32_dpp v4, v4, v4 row_ror:2 row_mask:0xf bank_mask:0xf
    v_add_f32_dpp v5, v5, v5 row_ror:2 row_mask:0xf bank_mask:0xf
    s_nop 0
    v_add_f32_dpp v4, v4, v4 row_ror:1 row_mask:0xf bank_mask:0xf
    v_add_f32_dpp v5, v5, v5 row_ror:1 row_mask:0xf bank_mask:0xf
    s_nop 0
    v_mul_f32 v4, s62, v4
    v_mul_f32 v6, v4, v4
    v_fma_f32 v7, v5, s62, -v6
    v_max_f32 v7, 0, v7
    v_add_f32 v5, 0x3727c5ac, v7
    v_rsq_f32 v5, v5
    s_nop 0
    buffer_store_dwordx2 v[4:5], v15, s[28:31], s61 offen offset:32 sc1
    v_mul_f32 v6, v5, v5
    v_mul_f32 v7, v7, v6
    v_add_f32 v7, 0x3727c5ac, v7
    v_rsq_f32 v7, v7
    s_nop 0
    v_mul_f32 v6, v5, v7
    v_mul_f32 v8, v4, v6
    v_sub_f32 v8, 0, v8
    v_lshlrev_b32 v10, 16, v48
    v_and_b32 v11, s63, v48
    v_pk_fma_f32 v[10:11], v[10:11], v[6:7], v[8:9] op_sel_hi:[1,0,0]
    v_cvt_pk_bf16_f32 v48, v10, v11
    v_lshlrev_b32 v12, 16, v49
    v_and_b32 v13, s63, v49
    v_pk_fma_f32 v[12:13], v[12:13], v[6:7], v[8:9] op_sel_hi:[1,0,0]
    v_cvt_pk_bf16_f32 v49, v12, v13
    v_lshlrev_b32 v10, 16, v50
    v_and_b32 v11, s63, v50
    v_pk_fma_f32 v[10:11], v[10:11], v[6:7], v[8:9] op_sel_hi:[1,0,0]
    v_cvt_pk_bf16_f32 v50, v10, v11
    v_lshlrev_b32 v12, 16, v51
    v_and_b32 v13, s63, v51
    v_pk_fma_f32 v[12:13], v[12:13], v[6:7], v[8:9] op_sel_hi:[1,0,0]
    v_cvt_pk_bf16_f32 v51, v12, v13
    buffer_store_dwordx4 v[48:51], v14, s[28:31], s60 offen offset:512 sc1
    s_add_u32 s60, s60, 524288
    v_lshlrev_b32 v10, 16, v52
    v_and_b32 v11, s63, v52
    v_pk_fma_f32 v[10:11], v[10:11], v[6:7], v[8:9] op_sel_hi:[1,0,0]
    v_cvt_pk_bf16_f32 v52, v10, v11
    v_lshlrev_b32 v12, 16, v53
    v_and_b32 v13, s63, v53
    v_pk_fma_f32 v[12:13], v[12:13], v[6:7], v[8:9] op_sel_hi:[1,0,0]
    v_cvt_pk_bf16_f32 v53, v12, v13
    v_lshlrev_b32 v10, 16, v54
    v_and_b32 v11, s63, v54
    v_pk_fma_f32 v[10:11], v[10:11], v[6:7], v[8:9] op_sel_hi:[1,0,0]
    v_cvt_pk_bf16_f32 v54, v10, v11
    v_lshlrev_b32 v12, 16, v55
    v_and_b32 v13, s63, v55
    v_pk_fma_f32 v[12:13], v[12:13], v[6:7], v[8:9] op_sel_hi:[1,0,0]
    v_cvt_pk_bf16_f32 v55, v12, v13
    buffer_store_dwordx4 v[52:55], v14, s[28:31], s60 offen offset:512 sc1
    s_add_u32 s60, s60, 524288
    v_lshlrev_b32 v10, 16, v56
    v_and_b32 v11, s63, v56
    v_pk_fma_f32 v[10:11], v[10:11], v[6:7], v[8:9] op_sel_hi:[1,0,0]
    v_cvt_pk_bf16_f32 v56, v10, v11
    v_lshlrev_b32 v12, 16, v57
    v_and_b32 v13, s63, v57
    v_pk_fma_f32 v[12:13], v[12:13], v[6:7], v[8:9] op_sel_hi:[1,0,0]
    v_cvt_pk_bf16_f32 v57, v12, v13
    v_lshlrev_b32 v10, 16, v58
    v_and_b32 v11, s63, v58
    v_pk_fma_f32 v[10:11], v[10:11], v[6:7], v[8:9] op_sel_hi:[1,0,0]
    v_cvt_pk_bf16_f32 v58, v10, v11
    v_lshlrev_b32 v12, 16, v59
    v_and_b32 v13, s63, v59
    v_pk_fma_f32 v[12:13], v[12:13], v[6:7], v[8:9] op_sel_hi:[1,0,0]
    v_cvt_pk_bf16_f32 v59, v12, v13
    buffer_store_dwordx4 v[56:59], v14, s[28:31], s60 offen offset:512 sc1
    s_add_u32 s60, s60, 524288
    v_lshlrev_b32 v10, 16, v60
    v_and_b32 v11, s63, v60
    v_pk_fma_f32 v[10:11], v[10:11], v[6:7], v[8:9] op_sel_hi:[1,0,0]
    v_cvt_pk_bf16_f32 v60, v10, v11
    v_lshlrev_b32 v12, 16, v61
    v_and_b32 v13, s63, v61
    v_pk_fma_f32 v[12:13], v[12:13], v[6:7], v[8:9] op_sel_hi:[1,0,0]
    v_cvt_pk_bf16_f32 v61, v12, v13
    v_lshlrev_b32 v10, 16, v62
    v_and_b32 v11, s63, v62
    v_pk_fma_f32 v[10:11], v[10:11], v[6:7], v[8:9] op_sel_hi:[1,0,0]
    v_cvt_pk_bf16_f32 v62, v10, v11
    v_lshlrev_b32 v12, 16, v63
    v_and_b32 v13, s63, v63
    v_pk_fma_f32 v[12:13], v[12:13], v[6:7], v[8:9] op_sel_hi:[1,0,0]
    v_cvt_pk_bf16_f32 v63, v12, v13
    buffer_store_dwordx4 v[60:63], v14, s[28:31], s60 offen offset:512 sc1
    s_add_u32 s60, s60, 524288
    s_lshr_b32 s60, s59, 2
    s_lshl_b32 s60, s60, 5
    s_add_u32 s60, s60, s40
    s_lshl_b32 s60, s60, 2
    s_add_u32 s60, s60, 0x20000
    s_waitcnt lgkmcnt(0)
    s_add_u32 s26, s26, 0x9e3779b9
    v_mov_b32 v10, s26
    v_mov_b32 v11, 0
    s_waitcnt vmcnt(0)
    buffer_store_dword v10, v11, s[28:31], s60 offen sc1
    s_barrier
    v_lshlrev_b32 v12, 3, v3
    s_lshl_b32 s54, s45, 7
    s_lshl_b32 s55, s51, 6
    s_add_u32 s54, s54, s55
    s_cmp_eq_u32 s49, 4
    s_cselect_b32 s54, 0x40000000, s54
    s_mov_b32 s32, s14
    s_and_b32 s33, s15, 0xffff
    s_mov_b32 s34, 0xac0
    s_mov_b32 s35, 0x00020000
    buffer_load_dwordx2 v[4:5], v12, s[32:35], s54 offen offset:0
    buffer_load_dwordx2 v[6:7], v12, s[32:35], s54 offen offset:16
    buffer_load_dwordx2 v[8:9], v12, s[32:35], s54 offen offset:32
    buffer_load_dwordx2 v[10:11], v12, s[32:35], s54 offen offset:48
    v_lshlrev_b32 v13, 10, v2
    v_lshl_add_u32 v13, v3, 4, v13
    v_lshlrev_b32 v14, 1, v2
    s_mov_b32 s32, s4
    s_and_b32 s33, s5, 0xffff
    s_mov_b32 s34, 0x200000
    s_mov_b32 s35, 0x00020000
    s_mov_b32 s36, s18
    s_and_b32 s37, s19, 0xffff
    s_mov_b32 s38, 0x1000
    s_mov_b32 s39, 0x00020000
    buffer_load_ushort v15, v14, s[36:39], s57 offen
    s_mov_b32 s58, 0x40000000
    s_waitcnt vmcnt(0)
C2_start:
    s_waitcnt vmcnt(8)
    v_lshlrev_b32 v32, 16, v4
    v_and_b32 v33, 0xffff0000, v4
    v_lshlrev_b32 v34, 16, v5
    v_and_b32 v35, 0xffff0000, v5
    v_lshlrev_b32 v36, 16, v6
    v_and_b32 v37, 0xffff0000, v6
    v_lshlrev_b32 v38, 16, v7
    v_and_b32 v39, 0xffff0000, v7
    v_lshlrev_b32 v40, 16, v8
    v_and_b32 v41, 0xffff0000, v8
    v_lshlrev_b32 v42, 16, v9
    v_and_b32 v43, 0xffff0000, v9
    v_lshlrev_b32 v44, 16, v10
    v_and_b32 v45, 0xffff0000, v10
    v_lshlrev_b32 v46, 16, v11
    v_and_b32 v47, 0xffff0000, v11
    s_lshl_b32 s55, s50, 6
    s_add_u32 s55, s55, 8192
    v_xor_b32 v19, s55, v0
    s_lshl_b32 s55, s51, 6
    v_xor_b32 v18, s55, v0
    v_mov_b64 v[80:81], 0
    v_mov_b64 v[82:83], 0
    v_mov_b64 v[84:85], 0
    v_mov_b64 v[86:87], 0
    v_mov_b64 v[88:89], 0
    v_mov_b64 v[90:91], 0
    v_mov_b64 v[92:93], 0
    v_mov_b64 v[94:95], 0
    v_mov_b64 v[96:97], 0
    v_mov_b64 v[98:99], 0
    v_mov_b64 v[100:101], 0
    v_mov_b64 v[102:103], 0
    v_mov_b64 v[104:105], 0
    v_mov_b64 v[106:107], 0
    v_mov_b64 v[108:109], 0
    v_mov_b64 v[110:111], 0
    s_mov_b32 s53, 0
    s_mov_b32 s59, 0
C2_loop:
    s_cmp_lg_u32 s59, 0
    s_cbranch_scc1 DS_53
    s_getreg_b32 s60, hwreg(HW_REG_IB_STS, 0, 4)
    s_cmp_ge_u32 s53, 24
    s_cselect_b32 s60, 0, s60
    s_or_b32 s60, s60, s59
    s_cbranch_scc1 DS_53
    v_mov_b32 v20, s26
    v_mov_b32 v21, 0
    s_waitcnt vmcnt(0)
    buffer_store_dword v20, v21, s[28:31], s58 offen sc1
    s_mov_b32 s59, 1
    v_mov_b32 v122, 0x3f80
    v_and_b32 v120, 1, v1
    v_lshlrev_b32 v120, 4, v120
    v_lshlrev_b32 v120, v120, v122
    v_lshrrev_b32 v121, 1, v2
    v_lshlrev_b32 v123, 2, v3
    v_sub_u32 v121, v121, v123
    v_cmp_eq_u32 vcc, 0, v121
    v_cmp_eq_u32 s[70:71], 1, v121
    s_nop 0
    v_cndmask_b32 v112, 0, v120, vcc
    v_cndmask_b32 v113, 0, v120, s[70:71]
    v_cmp_eq_u32 vcc, 2, v121
    v_cmp_eq_u32 s[70:71], 3, v121
    s_nop 0
    v_cndmask_b32 v114, 0, v120, vcc
    v_cndmask_b32 v115, 0, v120, s[70:71]
    v_cmp_eq_u32 vcc, 8, v121
    v_cmp_eq_u32 s[70:71], 9, v121
    s_nop 0
    v_cndmask_b32 v116, 0, v120, vcc
    v_cndmask_b32 v117, 0, v120, s[70:71]
    v_cmp_eq_u32 vcc, 10, v121
    v_cmp_eq_u32 s[70:71], 11, v121
    s_nop 0
    v_cndmask_b32 v118, 0, v120, vcc
    v_cndmask_b32 v119, 0, v120, s[70:71]
    s_lshl_b32 s54, s46, 1
    s_add_u32 s54, s54, s50
    s_mul_i32 s54, s54, 90112
    s_lshl_b32 s55, s45, 12
    s_add_u32 s54, s54, s55
    s_lshl_b32 s55, s51, 11
    s_add_u32 s54, s54, s55
    s_add_u32 s54, s54, 0x900000
DS_53:
    s_waitcnt lgkmcnt(0)
    s_barrier
    v_mfma_f32_32x32x16_bf16 v[32:47], v[80:83], v[84:87], v[32:47]
    ds_read_b64_tr_b16 v[48:49], v18 offset:0
    ds_read_b64_tr_b16 v[50:51], v18 offset:1024
    ds_read_b64_tr_b16 v[52:53], v19 offset:0
    ds_read_b64_tr_b16 v[54:55], v19 offset:1024
    v_mfma_f32_32x32x16_bf16 v[32:47], v[88:91], v[92:95], v[32:47]
    ds_read_b64_tr_b16 v[56:57], v18 offset:2048
    ds_read_b64_tr_b16 v[58:59], v18 offset:3072
    ds_read_b64_tr_b16 v[60:61], v19 offset:2048
    ds_read_b64_tr_b16 v[62:63], v19 offset:3072
    v_mfma_f32_32x32x16_bf16 v[32:47], v[96:99], v[100:103], v[32:47]
    ds_read_b64_tr_b16 v[64:65], v18 offset:4096
    ds_read_b64_tr_b16 v[66:67], v18 offset:5120
    ds_read_b64_tr_b16 v[68:69], v19 offset:4096
    ds_read_b64_tr_b16 v[70:71], v19 offset:5120
    v_mfma_f32_32x32x16_bf16 v[32:47], v[104:107], v[108:111], v[32:47]
    ds_read_b64_tr_b16 v[72:73], v18 offset:6144
    ds_read_b64_tr_b16 v[74:75], v18 offset:7168
    ds_read_b64_tr_b16 v[76:77], v19 offset:6144
    ds_read_b64_tr_b16 v[78:79], v19 offset:7168
    s_waitcnt lgkmcnt(0)
    s_barrier
    v_mfma_f32_32x32x16_bf16 v[32:47], v[48:51], v[52:55], v[32:47]
    ds_read_b64_tr_b16 v[80:81], v18 offset:16384
    ds_read_b64_tr_b16 v[82:83], v18 offset:17408
    ds_read_b64_tr_b16 v[84:85], v19 offset:16384
    ds_read_b64_tr_b16 v[86:87], v19 offset:17408
    ds_read_b64_tr_b16 v[88:89], v18 offset:18432
    v_mfma_f32_32x32x16_bf16 v[32:47], v[56:59], v[60:63], v[32:47]
    ds_read_b64_tr_b16 v[90:91], v18 offset:19456
    ds_read_b64_tr_b16 v[92:93], v19 offset:18432
    ds_read_b64_tr_b16 v[94:95], v19 offset:19456
    ds_read_b64_tr_b16 v[96:97], v18 offset:20480
    ds_read_b64_tr_b16 v[98:99], v18 offset:21504
    v_mfma_f32_32x32x16_bf16 v[32:47], v[64:67], v[68:71], v[32:47]
    ds_read_b64_tr_b16 v[100:101], v19 offset:20480
    ds_read_b64_tr_b16 v[102:103], v19 offset:21504
    ds_read_b64_tr_b16 v[104:105], v18 offset:22528
    ds_read_b64_tr_b16 v[106:107], v18 offset:23552
    ds_read_b64_tr_b16 v[108:109], v19 offset:22528
    v_mfma_f32_32x32x16_bf16 v[32:47], v[72:75], v[76:79], v[32:47]
    ds_read_b64_tr_b16 v[110:111], v19 offset:23552
    v_xor_b32 v18, 0x8000, v18
    v_xor_b32 v19, 0x8000, v19
    s_add_u32 s53, s53, 2
    s_cmp_lt_u32 s53, s72
    s_cbranch_scc1 C2_loop
    s_waitcnt lgkmcnt(0)
    v_mfma_f32_32x32x16_bf16 v[32:47], v[80:83], v[84:87], v[32:47]
    v_mfma_f32_32x32x16_bf16 v[32:47], v[88:91], v[92:95], v[32:47]
    v_mfma_f32_32x32x16_bf16 v[32:47], v[96:99], v[100:103], v[32:47]
    v_mfma_f32_32x32x16_bf16 v[32:47], v[104:107], v[108:111], v[32:47]
    v_mov_b32 v22, 0xbdd2d3e8
    v_mov_b32 v16, 0xc0135761
    v_lshlrev_b32 v13, 4, v1
    s_lshl_b32 s58, s46, 5
    s_add_u32 s58, s58, s45
    s_lshl_b32 s58, s58, 5
    s_add_u32 s58, s58, s40
    s_lshl_b32 s58, s58, 2
    s_add_u32 s58, s58, 0x30000
    s_nop 2
    v_pk_mul_f32 v[48:49], v[32:33], v[32:33]
    v_pk_mul_f32 v[50:51], v[34:35], v[34:35]
    v_pk_mul_f32 v[52:53], v[36:37], v[36:37]
    v_pk_mul_f32 v[54:55], v[38:39], v[38:39]
    v_pk_fma_f32 v[48:49], v[48:49], v[22:23], v[16:17] op_sel_hi:[1,0,0]
    v_pk_fma_f32 v[50:51], v[50:51], v[22:23], v[16:17] op_sel_hi:[1,0,0]
    v_pk_fma_f32 v[52:53], v[52:53], v[22:23], v[16:17] op_sel_hi:[1,0,0]
    v_pk_fma_f32 v[54:55], v[54:55], v[22:23], v[16:17] op_sel_hi:[1,0,0]
    v_pk_mul_f32 v[48:49], v[48:49], v[32:33]
    v_pk_mul_f32 v[50:51], v[50:51], v[34:35]
    v_pk_mul_f32 v[52:53], v[52:53], v[36:37]
    v_pk_mul_f32 v[54:55], v[54:55], v[38:39]
    v_exp_f32 v48, v48
    v_exp_f32 v49, v49
    v_exp_f32 v50, v50
    v_exp_f32 v51, v51
    v_exp_f32 v52, v52
    v_exp_f32 v53, v53
    v_exp_f32 v54, v54
    v_exp_f32 v55, v55
    v_add_f32 v48, 1.0, v48
    v_add_f32 v49, 1.0, v49
    v_add_f32 v50, 1.0, v50
    v_add_f32 v51, 1.0, v51
    v_add_f32 v52, 1.0, v52
    v_add_f32 v53, 1.0, v53
    v_add_f32 v54, 1.0, v54
    v_add_f32 v55, 1.0, v55
    v_rcp_f32 v48, v48
    v_rcp_f32 v49, v49
    v_rcp_f32 v50, v50
    v_rcp_f32 v51, v51
    v_rcp_f32 v52, v52
    v_rcp_f32 v53, v53
    v_rcp_f32 v54, v54
    v_rcp_f32 v55, v55
    v_pk_mul_f32 v[48:49], v[48:49], v[32:33]
    v_pk_mul_f32 v[50:51], v[50:51], v[34:35]
    v_pk_mul_f32 v[52:53], v[52:53], v[36:37]
    v_pk_mul_f32 v[54:55], v[54:55], v[38:39]
    v_cvt_pk_bf16_f32 v64, v48, v49
    v_cvt_pk_bf16_f32 v65, v50, v51
    v_cvt_pk_bf16_f32 v66, v52, v53
    v_cvt_pk_bf16_f32 v67, v54, v55
    buffer_store_dwordx4 v[64:67], v13, s[28:31], s54 offen offset:0 sc1
    v_pk_mul_f32 v[56:57], v[40:41], v[40:41]
    v_pk_mul_f32 v[58:59], v[42:43], v[42:43]
    v_pk_mul_f32 v[60:61], v[44:45], v[44:45]
    v_pk_mul_f32 v[62:63], v[46:47], v[46:47]
    v_pk_fma_f32 v[56:57], v[56:57], v[22:23], v[16:17] op_sel_hi:[1,0,0]
    v_pk_fma_f32 v[58:59], v[58:59], v[22:23], v[16:17] op_sel_hi:[1,0,0]
    v_pk_fma_f32 v[60:61], v[60:61], v[22:23], v[16:17] op_sel_hi:[1,0,0]
    v_pk_fma_f32 v[62:63], v[62:63], v[22:23], v[16:17] op_sel_hi:[1,0,0]
    v_pk_mul_f32 v[56:57], v[56:57], v[40:41]
    v_pk_mul_f32 v[58:59], v[58:59], v[42:43]
    v_pk_mul_f32 v[60:61], v[60:61], v[44:45]
    v_pk_mul_f32 v[62:63], v[62:63], v[46:47]
    v_exp_f32 v56, v56
    v_exp_f32 v57, v57
    v_exp_f32 v58, v58
    v_exp_f32 v59, v59
    v_exp_f32 v60, v60
    v_exp_f32 v61, v61
    v_exp_f32 v62, v62
    v_exp_f32 v63, v63
    v_add_f32 v56, 1.0, v56
    v_add_f32 v57, 1.0, v57
    v_add_f32 v58, 1.0, v58
    v_add_f32 v59, 1.0, v59
    v_add_f32 v60, 1.0, v60
    v_add_f32 v61, 1.0, v61
    v_add_f32 v62, 1.0, v62
    v_add_f32 v63, 1.0, v63
    v_rcp_f32 v56, v56
    v_rcp_f32 v57, v57
    v_rcp_f32 v58, v58
    v_rcp_f32 v59, v59
    v_rcp_f32 v60, v60
    v_rcp_f32 v61, v61
    v_rcp_f32 v62, v62
    v_rcp_f32 v63, v63
    v_pk_mul_f32 v[56:57], v[56:57], v[40:41]
    v_pk_mul_f32 v[58:59], v[58:59], v[42:43]
    v_pk_mul_f32 v[60:61], v[60:61], v[44:45]
    v_pk_mul_f32 v[62:63], v[62:63], v[46:47]
    v_cvt_pk_bf16_f32 v68, v56, v57
    v_cvt_pk_bf16_f32 v69, v58, v59
    v_cvt_pk_bf16_f32 v70, v60, v61
    v_cvt_pk_bf16_f32 v71, v62, v63
    buffer_store_dwordx4 v[68:71], v13, s[28:31], s54 offen offset:1024 sc1
    s_branch C3_setup
C3_start:
    v_mov_b32 v122, 0x3f80
    v_and_b32 v120, 1, v1
    v_lshlrev_b32 v120, 4, v120
    v_lshlrev_b32 v120, v120, v122
    v_lshrrev_b32 v121, 1, v2
    v_lshlrev_b32 v123, 2, v3
    v_sub_u32 v121, v121, v123
    v_cmp_eq_u32 vcc, 0, v121
    v_cmp_eq_u32 s[70:71], 1, v121
    s_nop 0
    v_cndmask_b32 v112, 0, v120, vcc
    v_cndmask_b32 v113, 0, v120, s[70:71]
    v_cmp_eq_u32 vcc, 2, v121
    v_cmp_eq_u32 s[70:71], 3, v121
    s_nop 0
    v_cndmask_b32 v114, 0, v120, vcc
    v_cndmask_b32 v115, 0, v120, s[70:71]
    v_cmp_eq_u32 vcc, 8, v121
    v_cmp_eq_u32 s[70:71], 9, v121
    s_nop 0
    v_cndmask_b32 v116, 0, v120, vcc
    v_cndmask_b32 v117, 0, v120, s[70:71]
    v_cmp_eq_u32 vcc, 10, v121
    v_cmp_eq_u32 s[70:71], 11, v121
    s_nop 0
    v_cndmask_b32 v118, 0, v120, vcc
    v_cndmask_b32 v119, 0, v120, s[70:71]
    s_mov_b32 s58, 0x40000000
C3_setup:
    s_lshl_b32 s55, s50, 6
    v_xor_b32 v18, s55, v0
    s_lshl_b32 s55, s51, 12
    s_add_u32 s55, s55, 8192
    v_lshl_add_u32 v19, v1, 4, s55
    v_mov_b64 v[80:81], 0
    v_mov_b64 v[82:83], 0
    v_mov_b64 v[84:85], 0
    v_mov_b64 v[86:87], 0
    v_mov_b64 v[88:89], 0
    v_mov_b64 v[90:91], 0
    v_mov_b64 v[92:93], 0
    v_mov_b64 v[94:95], 0
    v_mov_b64 v[96:97], 0
    v_mov_b64 v[98:99], 0
    v_mov_b64 v[100:101], 0
    v_mov_b64 v[102:103], 0
    v_mov_b64 v[104:105], 0
    v_mov_b64 v[106:107], 0
    v_mov_b64 v[108:109], 0
    v_mov_b64 v[110:111], 0
    v_lshlrev_b32 v14, 16, v15
    v_lshlrev_b32 v15, 16, v15
    v_mov_b64 v[32:33], v[14:15]
    v_mov_b64 v[34:35], v[14:15]
    v_mov_b64 v[36:37], v[14:15]
    v_mov_b64 v[38:39], v[14:15]
    v_mov_b64 v[40:41], v[14:15]
    v_mov_b64 v[42:43], v[14:15]
    v_mov_b64 v[44:45], v[14:15]
    v_mov_b64 v[46:47], v[14:15]
    v_bfe_u32 v22, v1, 1, 3
    v_xor_b32 v22, v22, v3
    s_lshl_b32 s55, s51, 2
    v_xor_b32 v22, s55, v22
    v_lshlrev_b32 v22, 4, v22
    v_lshl_add_u32 v22, v2, 7, v22
    s_lshl_b32 s55, s50, 12
    s_add_u32 s55, s55, 73728
    v_add_u32 v22, s55, v22
    v_xor_b32 v23, 32, v22
    v_mov_b32 v20, s26
    v_mov_b32 v21, 0
    s_waitcnt vmcnt(0)
    buffer_store_dword v20, v21, s[28:31], s58 offen sc1
    s_cmp_eq_u32 s49, 1
    s_cbranch_scc1 C3_go
    s_barrier
C3_go:
    s_mov_b32 s32, s20
    s_and_b32 s33, s21, 0xffff
    s_mov_b32 s34, 0x200000
    s_mov_b32 s35, 0x00020000
    s_mov_b32 s53, 0
C3_loop0:
    s_waitcnt lgkmcnt(0)
    s_barrier
    v_mfma_f32_32x32x16_bf16 v[32:47], v[80:83], v[84:87], v[32:47]
    ds_read_b128 v[48:51], v19 offset:0
    ds_read_b64_tr_b16 v[52:53], v18 offset:0
    ds_read_b64_tr_b16 v[54:55], v18 offset:1024
    v_mfma_f32_32x32x16_bf16 v[32:47], v[88:91], v[92:95], v[32:47]
    ds_read_b128 v[56:59], v19 offset:1024
    ds_read_b64_tr_b16 v[60:61], v18 offset:2048
    ds_read_b64_tr_b16 v[62:63], v18 offset:3072
    v_mfma_f32_32x32x16_bf16 v[32:47], v[96:99], v[100:103], v[32:47]
    ds_read_b128 v[64:67], v19 offset:2048
    ds_read_b64_tr_b16 v[68:69], v18 offset:4096
    ds_read_b64_tr_b16 v[70:71], v18 offset:5120
    v_mfma_f32_32x32x16_bf16 v[32:47], v[104:107], v[108:111], v[32:47]
    ds_read_b128 v[72:75], v19 offset:3072
    ds_read_b64_tr_b16 v[76:77], v18 offset:6144
    ds_read_b64_tr_b16 v[78:79], v18 offset:7168
    s_waitcnt lgkmcnt(0)
    s_barrier
    v_mfma_f32_32x32x16_bf16 v[32:47], v[48:51], v[52:55], v[32:47]
    ds_read_b128 v[80:83], v19 offset:16384
    ds_read_b64_tr_b16 v[84:85], v18 offset:16384
    ds_read_b64_tr_b16 v[86:87], v18 offset:17408
    ds_read_b128 v[88:91], v19 offset:17408
    v_mfma_f32_32x32x16_bf16 v[32:47], v[56:59], v[60:63], v[32:47]
    ds_read_b64_tr_b16 v[92:93], v18 offset:18432
    ds_read_b64_tr_b16 v[94:95], v18 offset:19456
    ds_read_b128 v[96:99], v19 offset:18432
    ds_read_b64_tr_b16 v[100:101], v18 offset:20480
    v_mfma_f32_32x32x16_bf16 v[32:47], v[64:67], v[68:71], v[32:47]
    ds_read_b64_tr_b16 v[102:103], v18 offset:21504
    ds_read_b128 v[104:107], v19 offset:19456
    ds_read_b64_tr_b16 v[108:109], v18 offset:22528
    ds_read_b64_tr_b16 v[110:111], v18 offset:23552
    v_mfma_f32_32x32x16_bf16 v[32:47], v[72:75], v[76:79], v[32:47]
    v_xor_b32 v18, 0x8000, v18
    v_xor_b32 v19, 0x8000, v19
    s_add_u32 s53, s53, 2
    s_cmp_lt_u32 s53, 22
    s_cbranch_scc1 C3_loop0
    ds_read_b128 v[24:27], v22
    ds_read_b128 v[28:31], v23
    s_xor_b32 s55, s50, s51
    s_lshl_b32 s57, s55, 6
    s_lshl_b32 s55, s55, 12
    v_xor_b32 v18, s57, v18
    v_xor_b32 v19, s55, v19
C3_loop1:
    s_waitcnt lgkmcnt(0)
    s_barrier
    v_mfma_f32_32x32x16_bf16 v[32:47], v[80:83], v[84:87], v[32:47]
    ds_read_b64_tr_b16 v[48:49], v18 offset:0
    ds_read_b64_tr_b16 v[50:51], v18 offset:1024
    ds_read_b128 v[52:55], v19 offset:0
    v_mfma_f32_32x32x16_bf16 v[32:47], v[88:91], v[92:95], v[32:47]
    ds_read_b64_tr_b16 v[56:57], v18 offset:2048
    ds_read_b64_tr_b16 v[58:59], v18 offset:3072
    ds_read_b128 v[60:63], v19 offset:1024
    v_mfma_f32_32x32x16_bf16 v[32:47], v[96:99], v[100:103], v[32:47]
    ds_read_b64_tr_b16 v[64:65], v18 offset:4096
    ds_read_b64_tr_b16 v[66:67], v18 offset:5120
    ds_read_b128 v[68:71], v19 offset:2048
    v_mfma_f32_32x32x16_bf16 v[32:47], v[104:107], v[108:111], v[32:47]
    ds_read_b64_tr_b16 v[72:73], v18 offset:6144
    ds_read_b64_tr_b16 v[74:75], v18 offset:7168
    ds_read_b128 v[76:79], v19 offset:3072
    s_waitcnt lgkmcnt(0)
    s_barrier
    v_mfma_f32_32x32x16_bf16 v[32:47], v[48:51], v[52:55], v[32:47]
    ds_read_b64_tr_b16 v[80:81], v18 offset:16384
    ds_read_b64_tr_b16 v[82:83], v18 offset:17408
    ds_read_b128 v[84:87], v19 offset:16384
    ds_read_b64_tr_b16 v[88:89], v18 offset:18432
    v_mfma_f32_32x32x16_bf16 v[32:47], v[56:59], v[60:63], v[32:47]
    ds_read_b64_tr_b16 v[90:91], v18 offset:19456
    ds_read_b128 v[92:95], v19 offset:17408
    ds_read_b64_tr_b16 v[96:97], v18 offset:20480
    ds_read_b64_tr_b16 v[98:99], v18 offset:21504
    v_mfma_f32_32x32x16_bf16 v[32:47], v[64:67], v[68:71], v[32:47]
    ds_read_b128 v[100:103], v19 offset:18432
    ds_read_b64_tr_b16 v[104:105], v18 offset:22528
    ds_read_b64_tr_b16 v[106:107], v18 offset:23552
    ds_read_b128 v[108:111], v19 offset:19456
    v_mfma_f32_32x32x16_bf16 v[32:47], v[72:75], v[76:79], v[32:47]
    v_xor_b32 v18, 0x8000, v18
    v_xor_b32 v19, 0x8000, v19
    s_add_u32 s53, s53, 2
    s_cmp_lt_u32 s53, 30
    s_cbranch_scc1 C3_loop1
    v_mfma_f32_32x32x16_bf16 v[32:47], v[112:115], v[24:27], v[32:47]
    v_mfma_f32_32x32x16_bf16 v[32:47], v[116:119], v[28:31], v[32:47]
    s_waitcnt lgkmcnt(0)
    v_mfma_f32_32x32x16_bf16 v[32:47], v[80:83], v[84:87], v[32:47]
    v_mfma_f32_32x32x16_bf16 v[32:47], v[88:91], v[92:95], v[32:47]
    v_mfma_f32_32x32x16_bf16 v[32:47], v[96:99], v[100:103], v[32:47]
    v_mfma_f32_32x32x16_bf16 v[32:47], v[104:107], v[108:111], v[32:47]
    s_lshl_b32 s55, s50, 12
    s_add_u32 s55, s55, 65536
    v_lshl_add_u32 v21, v2, 7, s55
    v_lshl_add_u32 v21, v3, 3, v21
    v_and_b32 v22, 7, v2
    s_lshl_b32 s55, s51, 2
    v_xor_b32 v22, s55, v22
    v_lshl_add_u32 v21, v22, 4, v21
    v_lshrrev_b32 v22, 3, v1
    v_and_b32 v23, 7, v1
    v_xor_b32 v4, v22, v23
    v_lshlrev_b32 v4, 4, v4
    v_lshl_add_u32 v4, v22, 7, v4
    s_lshl_b32 s55, s40, 11
    s_add_u32 s55, s55, 65536
    v_add_u32 v4, s55, v4
    v_lshlrev_b32 v5, 10, v22
    v_lshl_add_u32 v5, v23, 4, v5
    v_cvt_pk_bf16_f32 v48, v32, v33
    v_cvt_pk_bf16_f32 v49, v34, v35
    v_cvt_pk_bf16_f32 v50, v36, v37
    v_cvt_pk_bf16_f32 v51, v38, v39
    v_cvt_pk_bf16_f32 v52, v40, v41
    v_cvt_pk_bf16_f32 v53, v42, v43
    v_cvt_pk_bf16_f32 v54, v44, v45
    v_cvt_pk_bf16_f32 v55, v46, v47
    ds_write_b64 v21, v[48:49]
    v_xor_b32 v21, 16, v21
    ds_write_b64 v21, v[50:51]
    v_xor_b32 v21, 48, v21
    ds_write_b64 v21, v[52:53]
    v_xor_b32 v21, 16, v21
    ds_write_b64 v21, v[54:55]
    s_lshl_b32 s55, s47, 16
    s_lshl_b32 s57, s48, 7
    s_add_u32 s55, s55, s57
    s_lshl_b32 s57, s40, 14
    s_add_u32 s55, s55, s57
    s_add_u32 s57, s55, 8192
    s_waitcnt lgkmcnt(0)
    s_barrier
    ds_read_b128 v[56:59], v4
    ds_read_b128 v[60:63], v4 offset:1024
    s_waitcnt lgkmcnt(1)
    buffer_store_dwordx4 v[56:59], v5, s[32:35], s55 offen sc1
    s_waitcnt lgkmcnt(0)
    buffer_store_dwordx4 v[60:63], v5, s[32:35], s57 offen sc1
    s_branch L_done
A_wg:
    s_sub_u32 s42, s42, 32
    s_mov_b32 s49, 3
    s_waitcnt lgkmcnt(0)
    s_load_dword s26, s[24:25], 0x0
    s_mov_b32 s28, s24
    s_and_b32 s29, s25, 0xffff
    s_mov_b32 s30, 0xe00000
    s_mov_b32 s31, 0x00020000
    s_cmp_eq_u32 s40, 4
    s_cbranch_scc1 L_end
    s_cmp_eq_u32 s40, 5
    s_cbranch_scc1 A_misc
    s_waitcnt lgkmcnt(0)
    s_add_u32 s26, s26, 0x9e3779b9
A_att2:
    s_barrier
    s_lshl_b32 s50, s42, 2
    s_add_u32 s50, s50, s40
    s_and_b32 s51, s41, 1
    s_lshr_b32 s50, s42, 2
    s_mov_b32 s52, 0x74647666
    s_cmp_eq_u32 s50, 1
    s_cselect_b32 s52, 0x72625242, s52
    s_cmp_eq_u32 s50, 2
    s_cselect_b32 s52, 0x31215040, s52
    s_cmp_eq_u32 s50, 3
    s_cselect_b32 s52, 0xdccc3020, s52
    s_cmp_eq_u32 s50, 4
    s_cselect_b32 s52, 0xd8c8fcec, s52
    s_cmp_eq_u32 s50, 5
    s_cselect_b32 s52, 0xd4c4f8e8, s52
    s_cmp_eq_u32 s50, 6
    s_cselect_b32 s52, 0xffffffff, s52
    s_cmp_eq_u32 s50, 7
    s_cselect_b32 s52, 0xffffffff, s52
    s_and_b32 s50, s42, 3
    s_lshl_b32 s50, s50, 3
    s_lshr_b32 s52, s52, s50
    s_and_b32 s52, s52, 0xff
    s_cmp_eq_u32 s52, 0xff
    s_cbranch_scc1 L_done
    s_bfe_u32 s51, s52, 0x20006
    s_add_u32 s51, s51, 1
    s_bfe_u32 s53, s52, 0x20004
    s_lshl_b32 s3, s41, 2
    s_add_u32 s53, s53, s3
    s_and_b32 s54, s52, 15
    s_lshl_b32 s54, s54, 2
    s_add_u32 s55, s54, s40
    v_lshlrev_b32 v2, 4, v1
    v_mov_b32 v80, 0x3f803f80
    v_mov_b32 v81, 0x3f803f80
    v_mov_b32 v82, 0x3f803f80
    v_mov_b32 v83, 0x3f803f80
    v_and_b32 v3, 31, v1
    v_lshlrev_b32 v12, 9, v3
    ds_write_b128 v12, v[80:83] offset:49152
    s_lshl_b32 s3, s40, 10
    v_add_u32 v12, s3, v2
    v_lshrrev_b32 v14, 5, v1
    v_and_b32 v13, 15, v1
    v_lshlrev_b32 v13, 4, v13
    v_lshl_add_u32 v13, v14, 8, v13
    v_add_u32 v13, 24576, v13
    v_add_u32 v13, s3, v13
    v_mov_b32 v15, 49152
    v_mov_b32 v26, 4096
    v_cmp_gt_u32 vcc, 16, v3
    v_lshlrev_b32 v14, 2, v14
    v_sub_u32 v14, v3, v14
    v_cndmask_b32 v13, v15, v13, vcc
    v_cndmask_b32 v26, 0, v26, vcc
    v_cmp_le_i32 s[56:57], 0, v14
    v_cmp_le_i32 s[58:59], 1, v14
    v_cmp_le_i32 s[60:61], 2, v14
    v_cmp_le_i32 s[62:63], 3, v14
    v_cmp_le_i32 s[64:65], 8, v14
    v_cmp_le_i32 s[66:67], 9, v14
    v_cmp_le_i32 s[68:69], 10, v14
    v_cmp_le_i32 s[70:71], 11, v14
    v_cmp_le_i32 s[72:73], 16, v14
    v_cmp_le_i32 s[74:75], 17, v14
    v_cmp_le_i32 s[76:77], 18, v14
    v_cmp_le_i32 s[78:79], 19, v14
    v_cmp_le_i32 s[80:81], 24, v14
    v_cmp_le_i32 s[82:83], 25, v14
    v_cmp_le_i32 s[84:85], 26, v14
    v_cmp_le_i32 s[86:87], 27, v14
    v_mov_b32 v14, 0xffff
    v_mov_b32 v15, 0xffff0000
    v_cndmask_b32 v18, 0, v14, s[56:57]
    v_cndmask_b32 v3, 0, v15, s[58:59]
    v_or_b32 v18, v18, v3
    v_cndmask_b32 v19, 0, v14, s[60:61]
    v_cndmask_b32 v3, 0, v15, s[62:63]
    v_or_b32 v19, v19, v3
    v_cndmask_b32 v20, 0, v14, s[64:65]
    v_cndmask_b32 v3, 0, v15, s[66:67]
    v_or_b32 v20, v20, v3
    v_cndmask_b32 v21, 0, v14, s[68:69]
    v_cndmask_b32 v3, 0, v15, s[70:71]
    v_or_b32 v21, v21, v3
    v_cndmask_b32 v22, 0, v14, s[72:73]
    v_cndmask_b32 v3, 0, v15, s[74:75]
    v_or_b32 v22, v22, v3
    v_cndmask_b32 v23, 0, v14, s[76:77]
    v_cndmask_b32 v3, 0, v15, s[78:79]
    v_or_b32 v23, v23, v3
    v_cndmask_b32 v24, 0, v14, s[80:81]
    v_cndmask_b32 v3, 0, v15, s[82:83]
    v_or_b32 v24, v24, v3
    v_cndmask_b32 v25, 0, v14, s[84:85]
    v_cndmask_b32 v3, 0, v15, s[86:87]
    v_or_b32 v25, v25, v3
    s_lshr_b32 s3, s54, 2
    s_add_u32 s50, s3, s51
    s_sub_u32 s50, s50, 1
    s_sub_u32 s3, s3, 2
    v_and_b32 v14, 7, v1
    v_add_u32 v14, s3, v14
    v_max_i32 v14, 0, v14
    v_min_i32 v14, s50, v14
    v_lshrrev_b32 v15, 3, v1
    v_min_u32 v15, 2, v15
    v_lshl_add_u32 v14, v15, 6, v14
    v_lshlrev_b32 v14, 7, v14
    s_lshr_b32 s50, s53, 3
    s_lshl_b32 s50, s50, 11
    s_and_b32 s3, s53, 4
    s_lshl_b32 s3, s3, 1
    s_add_u32 s50, s50, s3
    s_add_u32 s50, s50, 0x28000
    s_lshl_b32 s3, s53, 16
    s_lshl_b32 s38, s55, 10
    s_add_u32 s38, s38, s3
    s_add_u32 s38, s38, 0x100000
    s_lshl_b32 s34, s55, 10
    s_add_u32 s34, s34, s3
    s_add_u32 s34, s34, 0x2fe000
    s_lshl_b32 s36, s40, 10
    s_mov_b32 s35, s55
    s_add_u32 s33, s51, 2
    s_cmp_eq_u32 s40, 0
    s_cbranch_scc0 AT_nopoll
    s_mov_b32 s37, 0
W_54:
    buffer_load_dwordx2 v[8:9], v14, s[28:31], s50 offen sc1
    s_waitcnt vmcnt(0)
    v_xor_b32 v8, s26, v8
    v_xor_b32 v9, s26, v9
    v_or_b32 v8, v8, v9
    v_cmp_ne_u32 vcc, 0, v8
    s_cbranch_vccz WD_55
    s_sleep 20
    s_add_u32 s37, s37, 1
    s_cmp_lt_u32 s37, 20000
    s_cbranch_scc1 W_54
WD_55:
AT_nopoll:
    s_barrier
    buffer_load_dwordx4 v[4:7], v2, s[28:31], s38 offen sc1
AT_stage:
    s_cmp_lt_u32 s35, 8
    s_cselect_b32 s37, 0x40000000, s34
    s_mov_b32 m0, s36
    s_add_u32 s32, s37, 0x200000
    buffer_load_dwordx4 v2, s[28:31], s37 offen sc1 lds
    s_add_u32 m0, s36, 24576
    s_add_u32 s34, s34, 4096
    buffer_load_dwordx4 v2, s[28:31], s32 offen sc1 lds
    s_add_u32 s36, s36, 4096
    s_add_u32 s35, s35, 4
    s_sub_u32 s33, s33, 1
    s_cmp_lg_u32 s33, 0
    s_cbranch_scc1 AT_stage
    s_lshl_b32 s32, s55, 5
    s_add_u32 s32, s32, s53
    s_lshl_b32 s33, s54, 3
    s_add_u32 s33, s33, s53
    s_lshl_b32 s33, s33, 5
    s_add_u32 s33, s33, s40
    s_lshl_b32 s33, s33, 2
    s_add_u32 s33, s33, 0x40000
    s_lshl_b32 s32, s32, 10
    s_add_u32 s32, s32, 0xb00000
    s_mov_b32 s39, 0
    s_waitcnt vmcnt(0) lgkmcnt(0)
    s_barrier
    s_sub_u32 s34, s2, 256
    s_lshl_b32 s34, s34, 7
    s_add_u32 s34, s34, 0x50000
    s_cmp_eq_u32 s40, 0
    s_cselect_b32 s34, s34, 0x40000000
    v_mov_b32 v14, s26
    v_mov_b32 v15, 0
    s_waitcnt vmcnt(0)
    buffer_store_dword v14, v15, s[28:31], s34 offen sc1
AT_unit:
    s_add_u32 s38, s38, 4096
    s_add_u32 s34, s39, 1
    s_cmp_lt_u32 s34, s51
    s_cselect_b32 s34, s38, 0x40000000
    buffer_load_dwordx4 v[8:11], v2, s[28:31], s34 offen sc1
    s_min_u32 s37, s55, 7
    s_mov_b32 s35, 0
AT_redo:
    ds_read_b128 v[112:115], v12 offset:8192
    ds_read_b128 v[116:119], v12 offset:0
    ds_read_b128 v[28:31], v12 offset:7168
    ds_read_b128 v[96:99], v13 offset:8192
    ds_read_b128 v[100:103], v13 offset:8704
    ds_read_b128 v[104:107], v13 offset:0
    ds_read_b128 v[108:111], v13 offset:512
    s_waitcnt lgkmcnt(6)
    v_mfma_f32_32x32x16_bf16 v[32:47], v[112:115], v[4:7], 0
    s_cmp_lt_u32 s55, 8
    s_cbranch_scc1 AT_notail
    s_waitcnt lgkmcnt(5)
    v_mfma_f32_32x32x16_bf16 v[80:95], v[116:119], v[4:7], 0
    s_nop 10
    s_branch AT_tailok
AT_notail:
    v_mov_b32 v80, 0xf149f2ca
    v_mov_b32 v81, 0xf149f2ca
    v_mov_b32 v82, 0xf149f2ca
    v_mov_b32 v83, 0xf149f2ca
    v_mov_b32 v84, 0xf149f2ca
    v_mov_b32 v85, 0xf149f2ca
    v_mov_b32 v86, 0xf149f2ca
    v_mov_b32 v87, 0xf149f2ca
    v_mov_b32 v88, 0xf149f2ca
    v_mov_b32 v89, 0xf149f2ca
    v_mov_b32 v90, 0xf149f2ca
    v_mov_b32 v91, 0xf149f2ca
    v_mov_b32 v92, 0xf149f2ca
    v_mov_b32 v93, 0xf149f2ca
    v_mov_b32 v94, 0xf149f2ca
    v_mov_b32 v95, 0xf149f2ca
AT_tailok:
    v_cndmask_b32 v32, v80, v32, s[56:57]
    v_cndmask_b32 v33, v81, v33, s[58:59]
    v_cndmask_b32 v34, v82, v34, s[60:61]
    v_cndmask_b32 v35, v83, v35, s[62:63]
    v_cndmask_b32 v36, v84, v36, s[64:65]
    v_cndmask_b32 v37, v85, v37, s[66:67]
    v_cndmask_b32 v38, v86, v38, s[68:69]
    v_cndmask_b32 v39, v87, v39, s[70:71]
    v_cndmask_b32 v40, v88, v40, s[72:73]
    v_cndmask_b32 v41, v89, v41, s[74:75]
    v_cndmask_b32 v42, v90, v42, s[76:77]
    v_cndmask_b32 v43, v91, v43, s[78:79]
    v_cndmask_b32 v44, v92, v44, s[80:81]
    v_cndmask_b32 v45, v93, v45, s[82:83]
    v_cndmask_b32 v46, v94, v46, s[84:85]
    v_cndmask_b32 v47, v95, v47, s[86:87]
    v_max_f32 v16, v32, v33
    v_max3_f32 v16, v34, v35, v16
    v_max3_f32 v16, v36, v37, v16
    v_max3_f32 v16, v38, v39, v16
    v_max3_f32 v16, v40, v41, v16
    v_max3_f32 v16, v42, v43, v16
    v_max3_f32 v16, v44, v45, v16
    v_max3_f32 v16, v46, v47, v16
    s_mul_i32 s36, s35, s37
    s_cmp_eq_u32 s36, 0
    s_cbranch_scc1 AT_p1done
    v_add_u32 v3, 7168, v12
AT_max:
    ds_read_b128 v[112:115], v3
    v_subrev_u32 v3, 1024, v3
    s_waitcnt lgkmcnt(0)
    v_mfma_f32_32x32x16_bf16 v[48:63], v[112:115], v[4:7], 0
    s_sub_u32 s36, s36, 1
    s_nop 11
    v_max3_f32 v16, v48, v49, v16
    v_max3_f32 v16, v50, v51, v16
    v_max3_f32 v16, v52, v53, v16
    v_max3_f32 v16, v54, v55, v16
    v_max3_f32 v16, v56, v57, v16
    v_max3_f32 v16, v58, v59, v16
    v_max3_f32 v16, v60, v61, v16
    v_max3_f32 v16, v62, v63, v16
    s_cmp_lg_u32 s36, 0
    s_cbranch_scc1 AT_max
AT_p1done:
    v_mov_b32 v17, v16
    s_nop 1
    v_permlane32_swap_b32 v16, v17
    s_nop 1
    v_max_f32 v16, v16, v17
    v_pk_add_f32 v[48:49], v[32:33], v[16:17] op_sel_hi:[1,0] neg_lo:[0,1] neg_hi:[0,1]
    v_pk_add_f32 v[50:51], v[34:35], v[16:17] op_sel_hi:[1,0] neg_lo:[0,1] neg_hi:[0,1]
    v_pk_add_f32 v[52:53], v[36:37], v[16:17] op_sel_hi:[1,0] neg_lo:[0,1] neg_hi:[0,1]
    v_pk_add_f32 v[54:55], v[38:39], v[16:17] op_sel_hi:[1,0] neg_lo:[0,1] neg_hi:[0,1]
    v_pk_add_f32 v[56:57], v[40:41], v[16:17] op_sel_hi:[1,0] neg_lo:[0,1] neg_hi:[0,1]
    v_pk_add_f32 v[58:59], v[42:43], v[16:17] op_sel_hi:[1,0] neg_lo:[0,1] neg_hi:[0,1]
    v_pk_add_f32 v[60:61], v[44:45], v[16:17] op_sel_hi:[1,0] neg_lo:[0,1] neg_hi:[0,1]
    v_pk_add_f32 v[62:63], v[46:47], v[16:17] op_sel_hi:[1,0] neg_lo:[0,1] neg_hi:[0,1]
    v_pk_add_f32 v[32:33], 0, v[16:17] op_sel_hi:[0,0] neg_lo:[0,1] neg_hi:[0,1]
    v_pk_add_f32 v[34:35], 0, v[16:17] op_sel_hi:[0,0] neg_lo:[0,1] neg_hi:[0,1]
    v_pk_add_f32 v[36:37], 0, v[16:17] op_sel_hi:[0,0] neg_lo:[0,1] neg_hi:[0,1]
    v_pk_add_f32 v[38:39], 0, v[16:17] op_sel_hi:[0,0] neg_lo:[0,1] neg_hi:[0,1]
    v_pk_add_f32 v[40:41], 0, v[16:17] op_sel_hi:[0,0] neg_lo:[0,1] neg_hi:[0,1]
    v_pk_add_f32 v[42:43], 0, v[16:17] op_sel_hi:[0,0] neg_lo:[0,1] neg_hi:[0,1]
    v_pk_add_f32 v[44:45], 0, v[16:17] op_sel_hi:[0,0] neg_lo:[0,1] neg_hi:[0,1]
    v_pk_add_f32 v[46:47], 0, v[16:17] op_sel_hi:[0,0] neg_lo:[0,1] neg_hi:[0,1]
    v_exp_f32 v48, v48
    s_waitcnt lgkmcnt(4)
    v_mfma_f32_32x32x16_bf16 v[64:79], v[28:31], v[4:7], v[32:47]
    ds_read_b128 v[28:31], v12 offset:6144
    v_exp_f32 v49, v49
    v_exp_f32 v50, v50
    v_exp_f32 v51, v51
    v_exp_f32 v52, v52
    v_exp_f32 v53, v53
    v_exp_f32 v54, v54
    v_exp_f32 v55, v55
    v_exp_f32 v56, v56
    v_exp_f32 v57, v57
    v_exp_f32 v58, v58
    v_exp_f32 v59, v59
    v_exp_f32 v60, v60
    v_exp_f32 v61, v61
    v_exp_f32 v62, v62
    v_exp_f32 v63, v63
    v_cvt_pk_bf16_f32 v48, v48, v49
    v_cvt_pk_bf16_f32 v49, v50, v51
    v_cvt_pk_bf16_f32 v50, v52, v53
    v_cvt_pk_bf16_f32 v51, v54, v55
    v_cvt_pk_bf16_f32 v52, v56, v57
    v_cvt_pk_bf16_f32 v53, v58, v59
    v_cvt_pk_bf16_f32 v54, v60, v61
    v_cvt_pk_bf16_f32 v55, v62, v63
    v_and_b32 v56, v48, v18
    v_and_b32 v57, v49, v19
    v_and_b32 v58, v50, v20
    v_and_b32 v59, v51, v21
    v_and_b32 v60, v52, v22
    v_and_b32 v61, v53, v23
    v_and_b32 v62, v54, v24
    v_and_b32 v63, v55, v25
    v_xor_b32 v48, v48, v56
    v_xor_b32 v49, v49, v57
    v_xor_b32 v50, v50, v58
    v_xor_b32 v51, v51, v59
    v_xor_b32 v52, v52, v60
    v_xor_b32 v53, v53, v61
    v_xor_b32 v54, v54, v62
    v_xor_b32 v55, v55, v63
    s_waitcnt lgkmcnt(0)
    s_cmp_eq_u32 s37, 0
    s_cbranch_scc1 AT_x0
    v_mfma_f32_32x32x16_bf16 v[80:95], v[96:99], v[56:59], 0
    v_exp_f32 v64, v64
    v_exp_f32 v65, v65
    v_exp_f32 v66, v66
    v_exp_f32 v67, v67
    v_mfma_f32_32x32x16_bf16 v[80:95], v[100:103], v[60:63], v[80:95]
    ds_read_b128 v[96:99], v13 offset:7168
    ds_read_b128 v[100:103], v13 offset:7680
    v_exp_f32 v68, v68
    v_exp_f32 v69, v69
    v_exp_f32 v70, v70
    v_exp_f32 v71, v71
    v_mfma_f32_32x32x16_bf16 v[80:95], v[104:107], v[48:51], v[80:95]
    v_exp_f32 v72, v72
    v_exp_f32 v73, v73
    v_exp_f32 v74, v74
    v_exp_f32 v75, v75
    v_mfma_f32_32x32x16_bf16 v[80:95], v[108:111], v[52:55], v[80:95]
    v_exp_f32 v76, v76
    v_exp_f32 v77, v77
    v_exp_f32 v78, v78
    v_exp_f32 v79, v79
    v_mfma_f32_32x32x16_bf16 v[48:63], v[28:31], v[4:7], v[32:47]
    ds_read_b128 v[28:31], v12 offset:5120
    v_cvt_pk_bf16_f32 v64, v64, v65
    v_cvt_pk_bf16_f32 v65, v66, v67
    v_cvt_pk_bf16_f32 v66, v68, v69
    v_cvt_pk_bf16_f32 v67, v70, v71
    v_cvt_pk_bf16_f32 v68, v72, v73
    v_cvt_pk_bf16_f32 v69, v74, v75
    v_cvt_pk_bf16_f32 v70, v76, v77
    v_cvt_pk_bf16_f32 v71, v78, v79
    s_nop 0
    s_cmp_eq_u32 s37, 1
    s_cbranch_scc1 AT_xB
    s_waitcnt lgkmcnt(0)
    v_mfma_f32_32x32x16_bf16 v[80:95], v[96:99], v[64:67], v[80:95]
    v_exp_f32 v48, v48
    v_exp_f32 v49, v49
    v_exp_f32 v50, v50
    v_exp_f32 v51, v51
    v_mfma_f32_32x32x16_bf16 v[80:95], v[100:103], v[68:71], v[80:95]
    ds_read_b128 v[96:99], v13 offset:6144
    ds_read_b128 v[100:103], v13 offset:6656
    v_exp_f32 v52, v52
    v_exp_f32 v53, v53
    v_exp_f32 v54, v54
    v_exp_f32 v55, v55
    v_mfma_f32_32x32x16_bf16 v[64:79], v[28:31], v[4:7], v[32:47]
    ds_read_b128 v[28:31], v12 offset:4096
    v_exp_f32 v56, v56
    v_exp_f32 v57, v57
    v_exp_f32 v58, v58
    v_exp_f32 v59, v59
    v_exp_f32 v60, v60
    v_exp_f32 v61, v61
    v_exp_f32 v62, v62
    v_exp_f32 v63, v63
    v_cvt_pk_bf16_f32 v48, v48, v49
    v_cvt_pk_bf16_f32 v49, v50, v51
    v_cvt_pk_bf16_f32 v50, v52, v53
    v_cvt_pk_bf16_f32 v51, v54, v55
    v_cvt_pk_bf16_f32 v52, v56, v57
    v_cvt_pk_bf16_f32 v53, v58, v59
    v_cvt_pk_bf16_f32 v54, v60, v61
    v_cvt_pk_bf16_f32 v55, v62, v63
    s_cmp_eq_u32 s37, 2
    s_cbranch_scc1 AT_xA
    s_waitcnt lgkmcnt(0)
    v_mfma_f32_32x32x16_bf16 v[80:95], v[96:99], v[48:51], v[80:95]
    v_exp_f32 v64, v64
    v_exp_f32 v65, v65
    v_exp_f32 v66, v66
    v_exp_f32 v67, v67
    v_mfma_f32_32x32x16_bf16 v[80:95], v[100:103], v[52:55], v[80:95]
    ds_read_b128 v[96:99], v13 offset:5120
    ds_read_b128 v[100:103], v13 offset:5632
    v_exp_f32 v68, v68
    v_exp_f32 v69, v69
    v_exp_f32 v70, v70
    v_exp_f32 v71, v71
    v_mfma_f32_32x32x16_bf16 v[48:63], v[28:31], v[4:7], v[32:47]
    ds_read_b128 v[28:31], v12 offset:3072
    v_exp_f32 v72, v72
    v_exp_f32 v73, v73
    v_exp_f32 v74, v74
    v_exp_f32 v75, v75
    v_exp_f32 v76, v76
    v_exp_f32 v77, v77
    v_exp_f32 v78, v78
    v_exp_f32 v79, v79
    v_cvt_pk_bf16_f32 v64, v64, v65
    v_cvt_pk_bf16_f32 v65, v66, v67
    v_cvt_pk_bf16_f32 v66, v68, v69
    v_cvt_pk_bf16_f32 v67, v70, v71
    v_cvt_pk_bf16_f32 v68, v72, v73
    v_cvt_pk_bf16_f32 v69, v74, v75
    v_cvt_pk_bf16_f32 v70, v76, v77
    v_cvt_pk_bf16_f32 v71, v78, v79
    s_cmp_eq_u32 s37, 3
    s_cbranch_scc1 AT_xB
    s_waitcnt lgkmcnt(0)
    v_mfma_f32_32x32x16_bf16 v[80:95], v[96:99], v[64:67], v[80:95]
    v_exp_f32 v48, v48
    v_exp_f32 v49, v49
    v_exp_f32 v50, v50
    v_exp_f32 v51, v51
    v_mfma_f32_32x32x16_bf16 v[80:95], v[100:103], v[68:71], v[80:95]
    ds_read_b128 v[96:99], v13 offset:4096
    ds_read_b128 v[100:103], v13 offset:4608
    v_exp_f32 v52, v52
    v_exp_f32 v53, v53
    v_exp_f32 v54, v54
    v_exp_f32 v55, v55
    v_mfma_f32_32x32x16_bf16 v[64:79], v[28:31], v[4:7], v[32:47]
    ds_read_b128 v[28:31], v12 offset:2048
    v_exp_f32 v56, v56
    v_exp_f32 v57, v57
    v_exp_f32 v58, v58
    v_exp_f32 v59, v59
    v_exp_f32 v60, v60
    v_exp_f32 v61, v61
    v_exp_f32 v62, v62
    v_exp_f32 v63, v63
    v_cvt_pk_bf16_f32 v48, v48, v49
    v_cvt_pk_bf16_f32 v49, v50, v51
    v_cvt_pk_bf16_f32 v50, v52, v53
    v_cvt_pk_bf16_f32 v51, v54, v55
    v_cvt_pk_bf16_f32 v52, v56, v57
    v_cvt_pk_bf16_f32 v53, v58, v59
    v_cvt_pk_bf16_f32 v54, v60, v61
    v_cvt_pk_bf16_f32 v55, v62, v63
    s_cmp_eq_u32 s37, 4
    s_cbranch_scc1 AT_xA
    s_waitcnt lgkmcnt(0)
    v_mfma_f32_32x32x16_bf16 v[80:95], v[96:99], v[48:51], v[80:95]
    v_exp_f32 v64, v64
    v_exp_f32 v65, v65
    v_exp_f32 v66, v66
    v_exp_f32 v67, v67
    v_mfma_f32_32x32x16_bf16 v[80:95], v[100:103], v[52:55], v[80:95]
    ds_read_b128 v[96:99], v13 offset:3072
    ds_read_b128 v[100:103], v13 offset:3584
    v_exp_f32 v68, v68
    v_exp_f32 v69, v69
    v_exp_f32 v70, v70
    v_exp_f32 v71, v71
    v_mfma_f32_32x32x16_bf16 v[48:63], v[28:31], v[4:7], v[32:47]
    ds_read_b128 v[28:31], v12 offset:1024
    v_exp_f32 v72, v72
    v_exp_f32 v73, v73
    v_exp_f32 v74, v74
    v_exp_f32 v75, v75
    v_exp_f32 v76, v76
    v_exp_f32 v77, v77
    v_exp_f32 v78, v78
    v_exp_f32 v79, v79
    v_cvt_pk_bf16_f32 v64, v64, v65
    v_cvt_pk_bf16_f32 v65, v66, v67
    v_cvt_pk_bf16_f32 v66, v68, v69
    v_cvt_pk_bf16_f32 v67, v70, v71
    v_cvt_pk_bf16_f32 v68, v72, v73
    v_cvt_pk_bf16_f32 v69, v74, v75
    v_cvt_pk_bf16_f32 v70, v76, v77
    v_cvt_pk_bf16_f32 v71, v78, v79
    s_cmp_eq_u32 s37, 5
    s_cbranch_scc1 AT_xB
    s_waitcnt lgkmcnt(0)
    v_mfma_f32_32x32x16_bf16 v[80:95], v[96:99], v[64:67], v[80:95]
    v_exp_f32 v48, v48
    v_exp_f32 v49, v49
    v_exp_f32 v50, v50
    v_exp_f32 v51, v51
    v_mfma_f32_32x32x16_bf16 v[80:95], v[100:103], v[68:71], v[80:95]
    ds_read_b128 v[96:99], v13 offset:2048
    ds_read_b128 v[100:103], v13 offset:2560
    v_exp_f32 v52, v52
    v_exp_f32 v53, v53
    v_exp_f32 v54, v54
    v_exp_f32 v55, v55
    v_mfma_f32_32x32x16_bf16 v[64:79], v[28:31], v[4:7], v[32:47]
    v_exp_f32 v56, v56
    v_exp_f32 v57, v57
    v_exp_f32 v58, v58
    v_exp_f32 v59, v59
    v_exp_f32 v60, v60
    v_exp_f32 v61, v61
    v_exp_f32 v62, v62
    v_exp_f32 v63, v63
    v_cvt_pk_bf16_f32 v48, v48, v49
    v_cvt_pk_bf16_f32 v49, v50, v51
    v_cvt_pk_bf16_f32 v50, v52, v53
    v_cvt_pk_bf16_f32 v51, v54, v55
    v_cvt_pk_bf16_f32 v52, v56, v57
    v_cvt_pk_bf16_f32 v53, v58, v59
    v_cvt_pk_bf16_f32 v54, v60, v61
    v_cvt_pk_bf16_f32 v55, v62, v63
    s_cmp_eq_u32 s37, 6
    s_cbranch_scc1 AT_xA
    s_waitcnt lgkmcnt(0)
    v_mfma_f32_32x32x16_bf16 v[80:95], v[96:99], v[48:51], v[80:95]
    v_exp_f32 v64, v64
    v_exp_f32 v65, v65
    v_exp_f32 v66, v66
    v_exp_f32 v67, v67
    v_mfma_f32_32x32x16_bf16 v[80:95], v[100:103], v[52:55], v[80:95]
    ds_read_b128 v[96:99], v13 offset:1024
    ds_read_b128 v[100:103], v13 offset:1536
    v_exp_f32 v68, v68
    v_exp_f32 v69, v69
    v_exp_f32 v70, v70
    v_exp_f32 v71, v71
    v_exp_f32 v72, v72
    v_exp_f32 v73, v73
    v_exp_f32 v74, v74
    v_exp_f32 v75, v75
    v_exp_f32 v76, v76
    v_exp_f32 v77, v77
    v_exp_f32 v78, v78
    v_exp_f32 v79, v79
    v_cvt_pk_bf16_f32 v64, v64, v65
    v_cvt_pk_bf16_f32 v65, v66, v67
    v_cvt_pk_bf16_f32 v66, v68, v69
    v_cvt_pk_bf16_f32 v67, v70, v71
    v_cvt_pk_bf16_f32 v68, v72, v73
    v_cvt_pk_bf16_f32 v69, v74, v75
    v_cvt_pk_bf16_f32 v70, v76, v77
    v_cvt_pk_bf16_f32 v71, v78, v79
AT_xB:
    s_waitcnt lgkmcnt(0)
    s_nop 0
    v_mfma_f32_32x32x16_bf16 v[80:95], v[96:99], v[64:67], v[80:95]
    v_mfma_f32_32x32x16_bf16 v[80:95], v[100:103], v[68:71], v[80:95]
    s_branch AT_p2done
AT_xA:
    s_waitcnt lgkmcnt(0)
    v_mfma_f32_32x32x16_bf16 v[80:95], v[96:99], v[48:51], v[80:95]
    v_mfma_f32_32x32x16_bf16 v[80:95], v[100:103], v[52:55], v[80:95]
    s_branch AT_p2done
AT_x0:
    v_mfma_f32_32x32x16_bf16 v[80:95], v[96:99], v[56:59], 0
    v_mfma_f32_32x32x16_bf16 v[80:95], v[100:103], v[60:63], v[80:95]
    v_mfma_f32_32x32x16_bf16 v[80:95], v[104:107], v[48:51], v[80:95]
    v_mfma_f32_32x32x16_bf16 v[80:95], v[108:111], v[52:55], v[80:95]
AT_p2done:
    s_mov_b32 s34, 0x5f800000
    s_nop 10
    v_cmp_ngt_f32 vcc, s34, v88
    s_cbranch_vccz AT_ok
    s_cmp_eq_u32 s35, 0
    s_mov_b32 s35, 1
    s_cbranch_scc1 AT_redo
AT_ok:
    v_add_u32 v12, 4096, v12
    v_add_u32 v13, v26, v13
    s_waitcnt vmcnt(0)
    v_mov_b32 v4, v8
    v_mov_b32 v5, v9
    v_mov_b32 v6, v10
    v_mov_b32 v7, v11
    v_mov_b32 v14, s26
    v_mov_b32 v15, 0
    s_sub_u32 s34, s33, 4096
    s_cmp_eq_u32 s39, 0
    s_cselect_b32 s34, 0x40000000, s34
    buffer_store_dword v14, v15, s[28:31], s34 offen sc1
    s_add_u32 s55, s55, 4
    s_add_u32 s39, s39, 1
    v_rcp_f32 v16, v88
    s_nop 0
    v_pk_mul_f32 v[80:81], v[80:81], v[16:17] op_sel_hi:[1,0]
    v_pk_mul_f32 v[82:83], v[82:83], v[16:17] op_sel_hi:[1,0]
    v_pk_mul_f32 v[84:85], v[84:85], v[16:17] op_sel_hi:[1,0]
    v_pk_mul_f32 v[86:87], v[86:87], v[16:17] op_sel_hi:[1,0]
    v_cvt_pk_bf16_f32 v28, v80, v81
    v_cvt_pk_bf16_f32 v29, v82, v83
    v_cvt_pk_bf16_f32 v30, v84, v85
    v_cvt_pk_bf16_f32 v31, v86, v87
    buffer_store_dwordx4 v[28:31], v2, s[28:31], s32 offen sc1
    s_add_u32 s32, s32, 131072
    s_add_u32 s33, s33, 4096
    s_cmp_lt_u32 s39, s51
    s_cbranch_scc1 AT_unit
    s_sub_u32 s33, s33, 4096
    v_mov_b32 v14, s26
    v_mov_b32 v15, 0
    s_waitcnt vmcnt(0)
    buffer_store_dword v14, v15, s[28:31], s33 offen sc1
    s_branch L_done
A_misc:
    s_waitcnt lgkmcnt(0)
    s_add_u32 s26, s26, 0x9e3779b9
    s_barrier
    s_lshl_b32 s63, s2, 2
    s_add_u32 s63, s63, 0x6000
    v_mov_b32 v6, s26
    v_mov_b32 v7, 0
    buffer_store_dword v6, v7, s[28:31], s63 offen sc1
    s_cmp_eq_u32 s2, 256
    s_cbranch_scc0 L_done
    v_lshlrev_b32 v2, 4, v1
    s_mov_b32 s50, 0x6000
    s_mov_b32 s52, 0
W_56:
    buffer_load_dwordx4 v[8:11], v2, s[28:31], s50 offen sc1
    buffer_load_dwordx4 v[12:15], v2, s[28:31], s50 offen offset:768 sc1
    s_waitcnt vmcnt(0)
    v_xor_b32 v8, s26, v8
    v_xor_b32 v9, s26, v9
    v_xor_b32 v10, s26, v10
    v_xor_b32 v11, s26, v11
    v_xor_b32 v12, s26, v12
    v_xor_b32 v13, s26, v13
    v_xor_b32 v14, s26, v14
    v_xor_b32 v15, s26, v15
    v_or3_b32 v8, v8, v9, v10
    v_or3_b32 v8, v8, v11, v12
    v_or3_b32 v8, v8, v13, v14
    v_or_b32 v8, v8, v15
    v_cmp_ne_u32 vcc, 0, v8
    s_cbranch_vccz WD_57
    s_sleep 64
    s_add_u32 s52, s52, 1
    s_cmp_lt_u32 s52, 20000
    s_cbranch_scc1 W_56
WD_57:
    buffer_store_dword v6, v7, s[28:31], 0 offen sc1
L_done:
    s_waitcnt vmcnt(0)
L_end:
    s_endpgm
K_code_end:
.section .rodata,"a"
.p2align 6
.amdhsa_kernel parallel_sum__sliding_block__mixer_token_mlp__prompt_kernel
  .amdhsa_next_free_vgpr 128
  .amdhsa_next_free_sgpr 102
  .amdhsa_accum_offset 128
  .amdhsa_group_segment_fixed_size 0
  .amdhsa_kernarg_size 88
  .amdhsa_user_sgpr_count 2
  .amdhsa_user_sgpr_kernarg_segment_ptr 1
  .amdhsa_system_sgpr_workgroup_id_x 1
.end_amdhsa_kernel
```
